```python
import torch

def _softmax(x, axis=-1):
    return torch.softmax(x, dim=axis)
def _gelu(x):
    return torch.nn.functional.gelu(x, approximate="tanh")
def _silu(x):
    return torch.nn.functional.silu(x)
def _sigmoid(x):
    return torch.sigmoid(x)
def _layernorm(x, axis=-1, eps=1e-5):
    m = x.mean(dim=axis, keepdim=True)
    v = x.var(dim=axis, keepdim=True, unbiased=False)
    return (x - m) / torch.sqrt(v + eps)
def _scatter_add(tgt, idx, src, axis=0):
    return tgt.clone().index_add_(axis, idx, src)
def _segment_sum(src, seg, n):
    out = torch.zeros((n,) + src.shape[1:], dtype=src.dtype)
    return out.index_add_(0, seg, src)
def _pad(x, pw):
    flat = tuple(v for pair in reversed(pw) for v in pair)
    return torch.nn.functional.pad(x, flat)

kernel_name = 'parallel_sum__sliding_block_cached__glu_gated_swiglu__decode'

def setup_inputs():

    _w = (lambda a: (lambda t: t.to(torch.bfloat16) if t.is_floating_point() else t)(torch.as_tensor(a)))
    def _A_setup():
        B, Sq, D = 4, 1, 640
        Hq, Hkv, Sk, Dh = 32, 32, 8192, 192
        assert Hq % Hkv == 0, (Hq, Hkv)
        return {
            "x": _w((lambda *s: torch.randn(*s, dtype=torch.bfloat16) * 0.05)(B, Sq, D)),
            "k_cache": _w((lambda *s: torch.randn(*s, dtype=torch.bfloat16) * 1.6)(B, Hkv, Sk, Dh)),
            "v_cache": _w((lambda *s: torch.randn(*s, dtype=torch.bfloat16) * 0.8)(B, Hkv, Sk, Dh)),
            "wq": _w((lambda *s: torch.randn(*s, dtype=torch.bfloat16) * 1.6)(D, Hq * Dh) * (D ** -0.5)),
            "wo": _w((lambda *s: torch.randn(*s, dtype=torch.bfloat16) * 0.8)(Hq * Dh, D) * ((Hq * Dh) ** -0.5)),
        }
    _A_in = _A_setup()

    def _B_setup():
        B, S, D, F = 4, 1, 640, 1536
        return {
            "x": _w((lambda *s: torch.randn(*s, dtype=torch.bfloat16) * 0.05)(B, S, D)),
            "w1": _w((lambda *s: torch.randn(*s, dtype=torch.bfloat16) * 0.4)(D, F) * (2.0 / D) ** 0.5),
            "w3": _w((lambda *s: torch.randn(*s, dtype=torch.bfloat16) * 0.4)(D, F) * (2.0 / D) ** 0.5),
            "w2": _w((lambda *s: torch.randn(*s, dtype=torch.bfloat16) * 0.4)(F, D) * (2.0 / F) ** 0.5),
        }
    _B_in = _B_setup()

    return {
        "A_x": _A_in["x"],
        "A_k_cache": _A_in["k_cache"],
        "A_v_cache": _A_in["v_cache"],
        "A_wq": _A_in["wq"],
        "A_wo": _A_in["wo"],
        "B_x": _B_in["x"],
        "B_w1": _B_in["w1"],
        "B_w3": _B_in["w3"],
        "B_w2": _B_in["w2"],
    }

def reference(A_x, A_k_cache, A_v_cache, A_wq, A_wo, B_x, B_w1, B_w3, B_w2):
    def _A_ref(x, k_cache, v_cache, wq, wo):
        B, Sq, D = x.shape
        Hq, Dh = 32, 192
        Hkv, Sk = k_cache.shape[1], k_cache.shape[2]
        W = min(4096, max(256, Sk // 4))
        rep = Hq // Hkv
        q = (lambda x, *d: x.permute(*d))((x @ wq).reshape(B, Sq, Hq, Dh), 0, 2, 1, 3)
        k = (lambda x, n, axis: torch.repeat_interleave(x, n, dim=axis))(k_cache[:, :, Sk - W:, :], rep, axis=1)
        v = (lambda x, n, axis: torch.repeat_interleave(x, n, dim=axis))(v_cache[:, :, Sk - W:, :], rep, axis=1)
        scores = torch.einsum("bhqd,bhkd->bhqk", q, k) * (Dh ** -0.5)
        p = _softmax(scores, axis=-1)
        o = torch.einsum("bhqk,bhkd->bhqd", p, v)
        return (lambda x, *d: x.permute(*d))(o, 0, 2, 1, 3).reshape(B, Sq, Hq * Dh) @ wo

    def _B_ref(x, w1, w3, w2):
        gate = torch.einsum("bsd,df->bsf", x, w1)
        up = torch.einsum("bsd,df->bsf", x, w3)
        h = _silu(gate) * up
        out = torch.einsum("bsf,fd->bsd", h, w2)
        return out

    x = A_x
    xn = _layernorm(x, axis=-1)
    return x + _A_ref(xn, A_k_cache, A_v_cache, A_wq, A_wo) + _B_ref(xn, B_w1, B_w3, B_w2)
```

```asm
; @launch grid=(256,1,1) block=(256,1,1) lds=143808
.amdgcn_target "amdgcn-amd-amdhsa--gfx950"
.text
.globl parallel_sum__sliding_block_cached__glu_gated_swiglu__decode_kernel
.p2align 8
.type parallel_sum__sliding_block_cached__glu_gated_swiglu__decode_kernel,@function
parallel_sum__sliding_block_cached__glu_gated_swiglu__decode_kernel:
    s_load_dwordx2 s[36:37], s[0:1], 32
    s_load_dwordx16 s[4:19], s[0:1], 0
    s_load_dwordx8 s[20:27], s[0:1], 64
    s_cmp_ge_u32 s2, 256
    s_cbranch_scc1 L_end
    s_and_b32 s73, s2, 7
    s_lshr_b32 s81, s2, 3
    s_lshr_b32 s74, s2, 6
    s_lshl_b32 s82, s74, 3
    s_lshr_b32 s82, 0x1e140a00, s82
    s_and_b32 s82, s82, 31
    s_xor_b32 s78, s73, s82
    s_and_b32 s75, s81, 7
    s_lshl3_add_u32 s61, s78, s75
    s_mul_i32 s61, s61, 30720
    s_add_u32 s38, s61, 30720
    s_mov_b32 s39, 0x20000
    v_lshlrev_b32 v45, 4, v0
    v_lshrrev_b32 v44, 6, v0
    s_getpc_b64 s[96:97]
L_pc:
    v_readfirstlane_b32 s72, v44
    s_waitcnt lgkmcnt(0)
    buffer_load_dwordx4 a[240:243], v45, s[36:39], s61 offen nt
    buffer_load_dword a240, v45, s[36:39], s61 offen
    s_add_u32 s61, s61, 4096
    buffer_load_dwordx4 a[240:243], v45, s[36:39], s61 offen nt
    buffer_load_dword a240, v45, s[36:39], s61 offen
    s_add_u32 s61, s61, 4096
    buffer_load_dwordx4 a[240:243], v45, s[36:39], s61 offen nt
    buffer_load_dword a240, v45, s[36:39], s61 offen
    s_add_u32 s61, s61, 4096
    buffer_load_dwordx4 a[240:243], v45, s[36:39], s61 offen nt
    buffer_load_dword a240, v45, s[36:39], s61 offen
    s_add_u32 s61, s61, 4096
    buffer_load_dwordx4 a[240:243], v45, s[36:39], s61 offen nt
    buffer_load_dword a240, v45, s[36:39], s61 offen
    s_add_u32 s61, s61, 4096
    buffer_load_dwordx4 a[240:243], v45, s[36:39], s61 offen nt
    buffer_load_dword a240, v45, s[36:39], s61 offen
    s_lshr_b32 s74, s2, 6
    s_and_b32 s75, s81, 7
    s_and_b32 s77, s81, 1
    v_and_b32 v0, 63, v0
    v_lshrrev_b32 v8, 3, v0
    v_and_b32 v9, 7, v0
    v_lshlrev_b32 v9, 4, v9
    s_mov_b64 s[44:45], s[4:5]
    s_movk_i32 s46, 5120
    s_mov_b32 s47, 0x20000
    v_lshlrev_b32 v18, 4, v0
    v_lshlrev_b32 v15, 2, v0
    s_mul_i32 s100, s72, 1280
    buffer_load_dwordx4 v[160:163], v18, s[44:47], s100 offen
    buffer_load_dword v164, v15, s[44:47], s100 offen offset:1024
    s_cmp_ge_u32 s74, 2
    s_cselect_b64 s[56:57], s[18:19], s[16:17]
    s_mov_b32 s58, 1966080
    s_mov_b32 s59, s47
    s_cmp_ge_u32 s81, 28
    s_cselect_b64 s[52:53], s[18:19], s[16:17]
    s_mul_i32 s88, s73, 384
    s_lshr_b32 s82, s81, 1
    s_mul_i32 s86, s82, 11
    s_lshr_b32 s86, s86, 5
    s_lshl_b32 s87, s86, 3
    s_lshr_b32 s87, 0x1e140a00, s87
    s_and_b32 s87, s87, 31
    s_xor_b32 s89, s73, s87
    s_sub_u32 s89, s89, s86
    s_mul_i32 s89, s89, 3
    s_add_u32 s89, s89, s82
    s_lshl_b32 s89, s89, 7
    s_and_b32 s82, s82, 1
    s_lshl_b32 s82, s82, 8
    s_add_u32 s82, s82, s88
    s_cmp_ge_u32 s81, 24
    s_cselect_b64 s[52:53], s[52:53], s[10:11]
    s_cselect_b32 s54, s58, 7864320
    s_mov_b32 s55, s47
    s_cselect_b32 s82, s82, s89
    s_cselect_b32 s83, 3, 12
    s_lshl_b32 s83, s83, 10
    s_lshl2_add_u32 s89, s77, s72
    s_mulk_i32 s89, 80
    s_mul_i32 s89, s89, s83
    s_add_u32 s98, s82, s89
    s_lshl_b32 s99, s83, 3
    v_lshrrev_b32 v10, 2, v0
    v_and_b32 v11, 3, v0
    v_lshrrev_b32 v12, 4, v0
    v_lshlrev_b32 v13, 4, v11
    v_mul_u32_u24 v17, 3072, v10
    v_add_u32 v17, v17, v13
    v_lshlrev_b32 v14, 5, v12
    v_xor_b32 v14, v14, v9
    v_mad_u32_u24 v46, s83, v8, v14
    s_mul_i32 s85, s72, 30720
    s_mul_i32 s82, s75, 5
    s_add_u32 s82, s82, s72
    s_mul_i32 s82, s82, 49152
    s_add_u32 s82, s82, s88
    s_and_b32 s89, s2, 64
    s_add_u32 s82, s82, s89
    s_addk_i32 s82, 128
    s_lshl_b32 s89, s72, 10
    s_add_u32 m0, s89, 132480
    s_load_dword s60, s[26:27], 0x68000
    s_lshl2_add_u32 s84, s81, s72
    s_min_u32 s84, s84, 86
    s_lshl_b32 s84, s84, 8
    s_add_u32 s96, s96, s84
    s_addc_u32 s97, s97, 0
    s_load_dword s1, s[96:97], 0
    s_load_dword s1, s[96:97], 64
    s_load_dword s1, s[96:97], 128
    s_load_dword s1, s[96:97], 192
    s_waitcnt vmcnt(12)
    s_cmp_lg_u32 s72, 0
    buffer_load_dwordx4 v17, s[56:59], s82 offen nt lds
    s_cbranch_scc1 L_noH
    s_mov_b32 m0, 136576
    s_add_u32 s82, s82, 196608
    buffer_load_dwordx4 v17, s[56:59], s82 offen nt lds
L_noH:
    s_waitcnt vmcnt(11)
    s_add_u32 m0, s85, 0
    s_nop 0
    buffer_load_dwordx4 v46, s[52:55], s98 offen nt lds
    s_lshr_b32 s76, s75, 1
    s_mov_b64 s[28:29], s[6:7]
    s_mov_b32 s30, 402653184
    s_mov_b32 s31, 0x20000
    s_lshl_b32 s82, s76, 5
    s_add_u32 s93, s82, s78
    s_lshl3_add_u32 s82, s93, s77
    s_add_u32 s25, s82, 6
    s_mul_i32 s80, s25, 393216
    v_and_b32 v2, 3, v8
    v_lshl_add_u32 v2, v44, 2, v2
    v_mul_u32_u24 v1, 384, v2
    v_lshrrev_b32 v2, 5, v0
    v_mul_u32_u24 v2, 66048, v2
    v_add3_u32 v1, v1, v9, v2
    s_lshl_b32 s79, s73, 5
    s_add_u32 s79, s79, s81
    s_mov_b64 s[32:33], s[8:9]
    s_mov_b64 s[40:41], s[20:21]
    s_mov_b64 s[64:65], s[22:23]
    s_mov_b64 s[48:49], s[26:27]
    s_mov_b64 s[68:69], s[26:27]
    s_mov_b32 s34, 402653184
    s_mov_b32 s35, 0x20000
    s_mov_b32 s42, 1966080
    s_mov_b32 s43, 0x20000
    s_mov_b32 s50, 3145728
    s_mov_b32 s51, 0x20000
    s_mov_b32 s66, 5120
    s_mov_b32 s67, 0x20000
    s_cmp_lt_u32 s72, 2
    s_cselect_b32 s70, 3145728, 0
    s_mov_b32 s71, 0x20000
    s_lshl2_add_u32 s82, s73, s72
    s_lshl_b32 s82, s82, 7
    s_add_u32 s82, s82, 442368
    s_lshl2_add_u32 s20, s81, s82
    s_mov_b32 s21, s81
    s_load_dword s1, s[26:27], s20
    s_mov_b32 s23, s82
    s_waitcnt vmcnt(10)
    s_add_u32 m0, s85, 1024
    s_add_u32 s98, s98, s99
    buffer_load_dwordx4 v46, s[52:55], s98 offen nt lds
    s_waitcnt vmcnt(9)
    s_add_u32 m0, s85, 2048
    s_add_u32 s98, s98, s99
    buffer_load_dwordx4 v46, s[52:55], s98 offen nt lds
    s_mul_i32 s81, s72, 1296
    s_add_u32 s81, s81, 127232
    v_add_u32 v14, s81, v18
    v_add_u32 v15, s81, v15
    v_mul_u32_u24 v63, 1296, v11
    s_mul_i32 s81, s77, 640
    s_add_u32 s81, s81, 127232
    v_lshl_add_u32 v63, v12, 3, v63
    v_add_u32 v62, s81, v63
    s_mul_i32 s81, s75, 160
    s_add_u32 s81, s81, 127232
    v_add_u32 v63, s81, v63
    s_lshl_b32 s93, s93, 7
    s_add_u32 s93, s93, 393216
    v_mul_u32_u24 v2, 1280, v8
    v_add_u32 v2, v2, v9
    v_mul_u32_u24 v3, 1280, v10
    v_add_u32 v3, v3, v13
    s_mul_i32 s86, s72, 320
    s_and_b32 s81, s72, 1
    s_lshl_b32 s82, s81, 6
    s_xor_b32 s81, s81, 1
    s_lshl_b32 s81, s81, 8
    s_add_u32 s87, s86, s81
    s_add_u32 s86, s86, s82
    s_mul_i32 s83, s78, 245760
    s_add_u32 s90, s83, s86
    s_add_u32 s91, s83, s87
    s_and_b32 s81, s72, 1
    s_mul_i32 s81, s81, 20416
    s_add_u32 s91, s91, s81
    s_lshl2_add_u32 s81, s73, s74
    s_lshl1_add_u32 s81, s81, s77
    s_mul_i32 s101, s81, 30720
    s_add_u32 s42, s101, 30720
    s_mov_b32 s57, s42
    s_mul_i32 s58, s76, 7680
    s_add_u32 s58, s58, s101
    s_add_u32 s42, s58, 7680
    s_sub_u32 s101, s101, s83
    s_lshl_b32 s82, s76, 6
    s_add_u32 s81, s81, s82
    s_mul_i32 s92, s81, 2560
    s_add_u32 s92, s92, 458752
    s_lshl2_add_u32 s81, s77, s72
    s_lshl_b32 s81, s81, 4
    s_add_u32 s88, s81, s93
    s_waitcnt vmcnt(8)
    s_add_u32 m0, s85, 3072
    s_add_u32 s98, s98, s99
    buffer_load_dwordx4 v46, s[52:55], s98 offen nt lds
    s_waitcnt vmcnt(7)
    s_add_u32 m0, s85, 4096
    s_add_u32 s98, s98, s99
    buffer_load_dwordx4 v46, s[52:55], s98 offen nt lds
    v_and_b32 v13, 3, v10
    v_lshl_add_u32 v13, v12, 3, v13
    v_lshlrev_b32 v19, 3, v11
    v_lshl_add_u32 v4, v13, 7, v19
    v_lshl_add_u32 v5, v13, 6, v19
    s_and_b32 s81, s72, 1
    s_lshl_b32 s81, s81, 5
    s_add_u32 s81, s81, 132480
    v_lshl_add_u32 v17, v10, 6, v19
    v_add_u32 v17, s81, v17
    v_and_b32 v16, 3, v8
    v_xor_b32 v16, s72, v16
    v_lshl_add_u32 v16, v16, 5, v19
    v_lshl_add_u32 v16, v10, 7, v16
    v_add_u32 v61, 61440, v16
    v_and_b32 v5, 0x7ff, v4
    v_lshrrev_b32 v13, 5, v0
    v_mul_u32_u24 v13, 30720, v13
    v_add_u32 v5, v5, v13
    s_and_b32 s81, s72, 2
    s_mul_i32 s81, s81, 30720
    s_and_b32 s82, s72, 1
    s_lshl_b32 s82, s82, 6
    s_add_u32 s81, s81, s82
    v_add_u32 v5, s81, v5
    s_xor_b32 s81, s72, 1
    s_lshl2_add_u32 s81, s81, 143760
    v_mov_b32 v3, s81
    v_add_u32 v4, s85, v4
    v_lshlrev_b32 v13, 4, v12
    v_lshl_add_u32 v60, v11, 8, v13
    v_lshl_add_u32 v47, v11, 7, v13
    v_and_b32 v13, 12, v0
    v_cmp_eq_u32 vcc, 0, v13
    v_mov_b32 v13, 0x7fffffff
    s_nop 0
    v_cndmask_b32 v60, v13, v60, vcc
    v_cndmask_b32 v47, v13, v47, vcc
    v_cmp_eq_u32 vcc, 0, v0
    s_nop 1
    v_cndmask_b32 v18, v13, v18, vcc
    s_waitcnt vmcnt(5)
    s_add_u32 m0, s85, 5120
    s_add_u32 s98, s98, s99
    buffer_load_dwordx4 v46, s[52:55], s98 offen nt lds
    v_mov_b32 v8, 0
    v_mov_b32 v13, 0x3f803f80
    v_dot2c_f32_bf16 v8, v160, v13
    v_lshlrev_b32 v166, 16, v160
    v_and_b32 v167, 0xffff0000, v160
    v_dot2c_f32_bf16 v8, v161, v13
    v_lshlrev_b32 v168, 16, v161
    v_and_b32 v169, 0xffff0000, v161
    v_dot2c_f32_bf16 v8, v162, v13
    v_lshlrev_b32 v170, 16, v162
    v_and_b32 v171, 0xffff0000, v162
    v_dot2c_f32_bf16 v8, v163, v13
    v_lshlrev_b32 v172, 16, v163
    v_and_b32 v173, 0xffff0000, v163
    v_dot2c_f32_bf16 v8, v164, v13
    v_lshlrev_b32 v174, 16, v164
    v_and_b32 v175, 0xffff0000, v164
    s_nop 0
    v_add_f32_dpp v8, v8, v8 quad_perm:[1,0,3,2] row_mask:0xf bank_mask:0xf
    s_nop 1
    v_add_f32_dpp v8, v8, v8 quad_perm:[2,3,0,1] row_mask:0xf bank_mask:0xf
    s_nop 1
    v_add_f32_dpp v8, v8, v8 row_half_mirror row_mask:0xf bank_mask:0xf
    s_nop 1
    v_add_f32_dpp v8, v8, v8 row_ror:8 row_mask:0xf bank_mask:0xf
    v_mov_b32 v9, v8
    s_nop 1
    v_permlane16_swap_b32 v8, v9
    v_add_f32 v8, v8, v9
    v_mov_b32 v9, v8
    s_nop 1
    v_permlane32_swap_b32 v8, v9
    v_add_f32 v8, v8, v9
    s_waitcnt vmcnt(5)
    s_add_u32 m0, s85, 6144
    s_add_u32 s98, s98, s99
    buffer_load_dwordx4 v46, s[52:55], s98 offen nt lds
    v_mul_f32 v8, 0xbacccccd, v8
    v_mov_b32 v10, 0
    v_mov_b32 v11, 0
    v_mov_b32 v9, v8
    v_pk_add_f32 v[12:13], v[166:167], v[8:9]
    v_pk_fma_f32 v[10:11], v[12:13], v[12:13], v[10:11]
    v_pk_add_f32 v[12:13], v[168:169], v[8:9]
    v_pk_fma_f32 v[10:11], v[12:13], v[12:13], v[10:11]
    v_pk_add_f32 v[12:13], v[170:171], v[8:9]
    v_pk_fma_f32 v[10:11], v[12:13], v[12:13], v[10:11]
    v_pk_add_f32 v[12:13], v[172:173], v[8:9]
    v_pk_fma_f32 v[10:11], v[12:13], v[12:13], v[10:11]
    v_pk_add_f32 v[12:13], v[174:175], v[8:9]
    v_pk_fma_f32 v[10:11], v[12:13], v[12:13], v[10:11]
    v_add_f32 v10, v10, v11
    v_cvt_pk_bf16_f32 v8, v8, v8
    s_nop 0
    v_add_f32_dpp v10, v10, v10 quad_perm:[1,0,3,2] row_mask:0xf bank_mask:0xf
    v_lshlrev_b32 v8, 16, v8
    s_nop 0
    v_add_f32_dpp v10, v10, v10 quad_perm:[2,3,0,1] row_mask:0xf bank_mask:0xf
    v_mov_b32 v9, v8
    s_nop 0
    v_add_f32_dpp v10, v10, v10 row_half_mirror row_mask:0xf bank_mask:0xf
    v_pk_add_f32 v[166:167], v[166:167], v[8:9]
    s_nop 0
    v_add_f32_dpp v10, v10, v10 row_ror:8 row_mask:0xf bank_mask:0xf
    v_pk_add_f32 v[168:169], v[168:169], v[8:9]
    v_pk_add_f32 v[170:171], v[170:171], v[8:9]
    v_pk_add_f32 v[172:173], v[172:173], v[8:9]
    v_pk_add_f32 v[174:175], v[174:175], v[8:9]
    v_mov_b32 v11, v10
    s_nop 1
    v_permlane16_swap_b32 v10, v11
    v_add_f32 v10, v10, v11
    v_mov_b32 v11, v10
    s_nop 1
    v_permlane32_swap_b32 v10, v11
    v_add_f32 v10, v10, v11
    s_waitcnt vmcnt(5)
    s_add_u32 m0, s85, 7168
    s_add_u32 s98, s98, s99
    buffer_load_dwordx4 v46, s[52:55], s98 offen nt lds
    v_mul_f32 v10, 0x3acccccd, v10
    v_cvt_pk_bf16_f32 v10, v10, v10
    v_and_b32 v10, 0xffff0000, v10
    v_add_f32 v10, 0x3727c5ac, v10
    v_cvt_pk_bf16_f32 v10, v10, v10
    v_lshlrev_b32 v10, 16, v10
    v_sqrt_f32 v10, v10
    v_cvt_pk_bf16_f32 v160, v166, v167
    v_cvt_pk_bf16_f32 v10, v10, v10
    v_lshlrev_b32 v10, 16, v10
    v_rcp_f32 v10, v10
    v_cvt_pk_bf16_f32 v161, v168, v169
    v_cvt_pk_bf16_f32 v162, v170, v171
    v_cvt_pk_bf16_f32 v163, v172, v173
    v_cvt_pk_bf16_f32 v164, v174, v175
    v_mov_b32 v11, v10
    v_lshlrev_b32 v12, 16, v160
    v_and_b32 v13, 0xffff0000, v160
    v_pk_mul_f32 v[12:13], v[12:13], v[10:11]
    v_cvt_pk_bf16_f32 v160, v12, v13
    v_lshlrev_b32 v12, 16, v161
    v_and_b32 v13, 0xffff0000, v161
    v_pk_mul_f32 v[12:13], v[12:13], v[10:11]
    v_cvt_pk_bf16_f32 v161, v12, v13
    v_lshlrev_b32 v12, 16, v162
    v_and_b32 v13, 0xffff0000, v162
    v_pk_mul_f32 v[12:13], v[12:13], v[10:11]
    v_cvt_pk_bf16_f32 v162, v12, v13
    v_lshlrev_b32 v12, 16, v163
    v_and_b32 v13, 0xffff0000, v163
    v_pk_mul_f32 v[12:13], v[12:13], v[10:11]
    v_cvt_pk_bf16_f32 v163, v12, v13
    v_lshlrev_b32 v12, 16, v164
    v_and_b32 v13, 0xffff0000, v164
    v_pk_mul_f32 v[12:13], v[12:13], v[10:11]
    v_cvt_pk_bf16_f32 v164, v12, v13
    ds_write_b128 v14, v[160:163]
    ds_write_b32 v15, v164 offset:1024
    s_lshl2_add_u32 s81, s72, 143744
    v_mov_b32 v8, s81
    v_mov_b32 v9, 0
    ds_write_b32 v8, v9
    ds_write_b32 v8, v9 offset:16
    v_cmp_le_u32 vcc, 54, v0
    s_nop 1
    v_cndmask_b32 v8, 0, 1, vcc
    s_mul_i32 s81, s74, 48
    s_mul_i32 s82, s77, 24
    s_add_u32 s81, s81, s82
    s_sub_u32 s81, s81, 192
    v_mul_u32_u24 v9, 24, v8
    v_lshl_add_u32 v10, v0, 2, s81
    v_sub_u32 v10, v10, v9
    v_lshrrev_b32 v9, 6, v10
    v_lshl_add_u32 v11, v8, 2, v9
    v_add_u32 v11, 24, v11
    v_bfe_u32 v12, v10, 5, 1
    v_lshl_add_u32 v12, v8, 1, v12
    v_lshlrev_b32 v12, 3, v12
    v_cmp_eq_u32 s[96:97], 1, v9
    v_cmp_le_u32 vcc, 48, v0
    s_nop 0
    s_and_b64 s[96:97], s[96:97], vcc
    v_cndmask_b32 v11, v11, v12, s[96:97]
    s_mul_i32 s81, s74, 6
    v_lshrrev_b32 v12, 4, v0
    v_lshl_add_u32 v12, v12, 1, s81
    v_cndmask_b32 v11, v12, v11, vcc
    v_lshlrev_b32 v12, 2, v0
    v_cndmask_b32 v10, v12, v10, vcc
    s_lshl_b32 s81, s76, 6
    s_lshl_b32 s82, s76, 5
    s_add_u32 s82, s82, 256
    v_and_b32 v12, 31, v10
    v_add_u32 v12, s82, v12
    v_and_b32 v10, 63, v10
    v_add_u32 v10, s81, v10
    v_cndmask_b32 v10, v10, v12, s[96:97]
    v_mul_u32_u24 v11, 1536, v11
    v_lshl_add_u32 v11, v10, 2, v11
    s_lshl_b32 s81, s73, 4
    s_add_u32 s81, s81, s72
    s_mul_i32 s81, s81, 3072
    v_add_u32 v11, s81, v11
    s_cmp_eq_u32 s72, 0
    s_cselect_b64 s[62:63], -1, s[96:97]
    s_and_b32 s63, s63, 0x0fffffff
    v_mov_b32 v12, 0x7fffffff
    v_cndmask_b32 v6, v12, v11, s[62:63]
    s_waitcnt vmcnt(5)
    s_add_u32 m0, s85, 8192
    s_add_u32 s98, s98, s99
    buffer_load_dwordx4 v46, s[52:55], s98 offen nt lds
    s_waitcnt vmcnt(5)
    s_add_u32 m0, s85, 9216
    s_add_u32 s98, s98, s99
    buffer_load_dwordx4 v46, s[52:55], s98 offen nt lds
    s_waitcnt vmcnt(5)
    s_add_u32 s61, s61, 4096
    buffer_load_dwordx4 a[240:243], v45, s[36:39], s61 offen nt
    buffer_load_dword a240, v45, s[36:39], s61 offen
    s_waitcnt vmcnt(6)
    s_add_u32 s61, s61, 4096
    buffer_load_dwordx4 a[240:243], v45, s[36:39], s61 offen nt
    buffer_load_dword a240, v45, s[36:39], s61 offen
    s_mov_b32 s38, 7864320
    s_waitcnt vmcnt(7)
    buffer_load_dwordx4 a[240:243], v45, s[40:43], s58 offen nt
    buffer_load_dword a240, v45, s[40:43], s58 offen
    s_waitcnt vmcnt(8)
    s_add_u32 s58, s58, 4096
    buffer_load_dwordx4 a[240:243], v45, s[40:43], s58 offen nt
    buffer_load_dword a240, v45, s[40:43], s58 offen
    s_mov_b32 s42, s57
    s_waitcnt vmcnt(8)
    buffer_load_dwordx4 v[64:67], v1, s[28:31], s80 offen offset:0 nt
    buffer_load_dwordx4 v[68:71], v1, s[28:31], s80 offen offset:128 nt
    buffer_load_dwordx4 v[72:75], v1, s[28:31], s80 offen offset:256 nt
    s_waitcnt lgkmcnt(0)
    s_barrier
    s_add_u32 s60, s60, 1
    ds_read2_b64 v[206:209], v62 offset0:0 offset1:4
    ds_read_b64_tr_b16 v[156:157], v16 offset:0
    ds_read_b64_tr_b16 v[158:159], v16 offset:2048
    ds_read2_b64 v[210:213], v62 offset0:8 offset1:12
    ds_read_b64_tr_b16 v[160:161], v16 offset:4096
    ds_read_b64_tr_b16 v[162:163], v16 offset:6144
    ds_read2_b64 v[214:217], v62 offset0:16 offset1:20
    ds_read_b64_tr_b16 v[164:165], v16 offset:8192
    ds_read_b64_tr_b16 v[166:167], v16 offset:30720
    ds_read2_b64 v[218:221], v62 offset0:24 offset1:28
    ds_read_b64_tr_b16 v[168:169], v16 offset:32768
    ds_read_b64_tr_b16 v[170:171], v16 offset:34816
    ds_read2_b64 v[222:225], v62 offset0:32 offset1:36
    ds_read_b64_tr_b16 v[172:173], v16 offset:36864
    ds_read_b64_tr_b16 v[174:175], v16 offset:38912
    s_add_u32 m0, s85, 10240
    s_add_u32 s100, s90, 0
    buffer_load_dwordx4 v2, s[36:39], s100 offen  lds
    ds_read2_b64 v[226:229], v62 offset0:40 offset1:44
    ds_read_b64_tr_b16 v[176:177], v61 offset:0
    ds_read_b64_tr_b16 v[178:179], v61 offset:2048
    ds_read2_b64 v[230:233], v62 offset0:48 offset1:52
    ds_read_b64_tr_b16 v[180:181], v61 offset:4096
    ds_read_b64_tr_b16 v[182:183], v61 offset:6144
    ds_read2_b64 v[234:237], v62 offset0:56 offset1:60
    ds_read_b64_tr_b16 v[184:185], v61 offset:8192
    ds_read_b64_tr_b16 v[186:187], v61 offset:30720
    ds_read2_b64 v[238:241], v62 offset0:64 offset1:68
    ds_read_b64_tr_b16 v[188:189], v61 offset:32768
    ds_read_b64_tr_b16 v[190:191], v61 offset:34816
    ds_read2_b64 v[242:245], v62 offset0:72 offset1:76
    ds_read_b64_tr_b16 v[192:193], v61 offset:36864
    ds_read_b64_tr_b16 v[194:195], v61 offset:38912
    s_waitcnt vmcnt(6)
    s_add_u32 s3, s80, 6144
    buffer_load_dwordx4 v[76:79], v1, s[28:31], s3 offen offset:0 nt
    buffer_load_dwordx4 v[80:83], v1, s[28:31], s3 offen offset:128 nt
    buffer_load_dwordx4 v[84:87], v1, s[28:31], s3 offen offset:256 nt
    s_barrier
    ds_read_b64 v[246:247], v63 offset:0
    ds_read_b64_tr_b16 v[196:197], v17 offset:0
    ds_read_b64 v[248:249], v63 offset:32
    ds_read_b64_tr_b16 v[198:199], v17 offset:1024
    ds_read_b64 v[250:251], v63 offset:64
    ds_read_b64_tr_b16 v[200:201], v17 offset:2048
    ds_read_b64 v[252:253], v63 offset:96
    ds_read_b64_tr_b16 v[202:203], v17 offset:3072
    ds_read_b64 v[254:255], v63 offset:128
    ds_read_b64_tr_b16 v[204:205], v17 offset:4096
    s_waitcnt lgkmcnt(15)
    v_mfma_f32_16x16x32_bf16 v[32:35], v[156:159], v[206:209], 0
    v_mfma_f32_16x16x32_bf16 v[36:39], v[160:163], v[210:213], 0
    v_mfma_f32_16x16x32_bf16 v[32:35], v[164:167], v[214:217], v[32:35]
    v_mfma_f32_16x16x32_bf16 v[36:39], v[168:171], v[218:221], v[36:39]
    v_mfma_f32_16x16x32_bf16 v[32:35], v[172:175], v[222:225], v[32:35]
    v_mfma_f32_16x16x32_bf16 v[36:39], v[176:179], v[226:229], v[36:39]
    v_mfma_f32_16x16x32_bf16 v[32:35], v[180:183], v[230:233], v[32:35]
    v_mfma_f32_16x16x32_bf16 v[36:39], v[184:187], v[234:237], v[36:39]
    s_waitcnt lgkmcnt(13)
    v_mfma_f32_16x16x32_bf16 v[32:35], v[188:191], v[238:241], v[32:35]
    s_waitcnt lgkmcnt(10)
    v_mfma_f32_16x16x32_bf16 v[36:39], v[192:195], v[242:245], v[36:39]
    s_add_u32 m0, s85, 14336
    s_add_u32 s100, s90, 128
    buffer_load_dwordx4 v2, s[36:39], s100 offen  lds
    s_waitcnt lgkmcnt(8)
    v_mfma_f32_16x16x16_bf16 v[40:43], v[196:197], v[246:247], 0
    s_waitcnt lgkmcnt(6)
    v_mfma_f32_16x16x16_bf16 v[40:43], v[198:199], v[248:249], v[40:43]
    s_waitcnt lgkmcnt(4)
    v_mfma_f32_16x16x16_bf16 v[40:43], v[200:201], v[250:251], v[40:43]
    s_waitcnt lgkmcnt(2)
    v_mfma_f32_16x16x16_bf16 v[40:43], v[202:203], v[252:253], v[40:43]
    s_waitcnt lgkmcnt(0)
    v_mfma_f32_16x16x16_bf16 v[40:43], v[204:205], v[254:255], v[40:43]
    s_mul_i32 s81, s79, 1536
    s_lshl_b32 s82, s72, 6
    s_add_u32 s81, s81, s82
    v_pk_add_f32 v[32:33], v[32:33], v[36:37]
    v_pk_add_f32 v[34:35], v[34:35], v[38:39]
    v_bfi_b32 v32, 7, s60, v32
    v_bfi_b32 v33, 7, s60, v33
    v_bfi_b32 v34, 7, s60, v34
    v_bfi_b32 v35, 7, s60, v35
    buffer_store_dwordx4 v[32:35], v60, s[48:51], s81 offen sc1
    v_bfi_b32 v40, 7, s60, v40
    v_bfi_b32 v41, 7, s60, v41
    v_bfi_b32 v42, 7, s60, v42
    v_bfi_b32 v43, 7, s60, v43
    buffer_store_dwordx4 v[40:43], v47, s[68:71], s81 offen offset:1024 sc1
    s_lshl_b32 s0, s60, 6
    v_mov_b32 v19, s0
    v_mul_u32_u24 v8, 43, v0
    v_lshrrev_b32 v8, 9, v8
    v_mul_u32_u24 v9, 12, v8
    v_sub_u32 v9, v0, v9
    s_mul_i32 s81, s72, 1536
    v_lshl_add_u32 v16, v9, 7, s81
    v_lshrrev_b32 v9, 1, v8
    v_mul_u32_u24 v9, 6144, v9
    v_and_b32 v8, 1, v8
    v_mul_u32_u24 v8, 66048, v8
    v_add3_u32 v16, v16, v8, v9
    v_cmp_gt_u32 vcc, 24, v0
    v_mov_b32 v8, 0x7fffffff
    s_nop 0
    v_cndmask_b32 v16, v8, v16, vcc
    s_cmp_eq_u32 s72, 3
    s_cselect_b32 s54, 66048, 0
    s_add_u32 s54, s54, s80
    s_lshr_b32 s55, s72, 1
    s_add_u32 s55, s55, 1
    s_mul_i32 s55, s55, 66048
    s_add_u32 s55, s55, s80
    v_and_b32 v57, 31, v0
    v_lshlrev_b32 v57, 2, v57
    s_waitcnt vmcnt(8)
    s_add_u32 s3, s80, 12288
    buffer_load_dwordx4 v[88:91], v1, s[28:31], s3 offen offset:0 nt
    buffer_load_dwordx4 v[92:95], v1, s[28:31], s3 offen offset:128 nt
    buffer_load_dwordx4 v[96:99], v1, s[28:31], s3 offen offset:256 nt
    s_barrier
    s_add_u32 m0, s85, 11264
    s_add_u32 s100, s90, 10240
    buffer_load_dwordx4 v2, s[36:39], s100 offen  lds
    s_waitcnt vmcnt(8)
    s_add_u32 s3, s80, 18432
    buffer_load_dwordx4 v[100:103], v1, s[28:31], s3 offen offset:0 nt
    buffer_load_dwordx4 v[104:107], v1, s[28:31], s3 offen offset:128 nt
    buffer_load_dwordx4 v[108:111], v1, s[28:31], s3 offen offset:256 nt
    s_barrier
    s_add_u32 m0, s85, 15360
    s_add_u32 s100, s90, 10368
    buffer_load_dwordx4 v2, s[36:39], s100 offen  lds
    s_waitcnt vmcnt(6)
    s_add_u32 s3, s80, 24576
    buffer_load_dwordx4 v[112:115], v1, s[28:31], s3 offen offset:0 nt
    buffer_load_dwordx4 v[116:119], v1, s[28:31], s3 offen offset:128 nt
    buffer_load_dwordx4 v[120:123], v1, s[28:31], s3 offen offset:256 nt
    s_barrier
    s_add_u32 m0, s85, 18432
    s_add_u32 s100, s91, 0
    buffer_load_dwordx4 v2, s[36:39], s100 offen  lds
    s_waitcnt vmcnt(6)
    s_add_u32 s3, s80, 30720
    buffer_load_dwordx4 v[124:127], v1, s[28:31], s3 offen offset:0 nt
    buffer_load_dwordx4 v[128:131], v1, s[28:31], s3 offen offset:128 nt
    buffer_load_dwordx4 v[132:135], v1, s[28:31], s3 offen offset:256 nt
    s_barrier
    s_add_u32 m0, s85, 12288
    s_add_u32 s100, s90, 20480
    buffer_load_dwordx4 v2, s[36:39], s100 offen  lds
    s_add_u32 m0, s85, 16384
    s_add_u32 s100, s90, 20608
    buffer_load_dwordx4 v2, s[36:39], s100 offen  lds
    s_waitcnt vmcnt(7)
    s_add_u32 s3, s80, 36864
    buffer_load_dwordx4 v[136:139], v1, s[28:31], s3 offen offset:0 nt
    buffer_load_dwordx4 v[140:143], v1, s[28:31], s3 offen offset:128 nt
    buffer_load_dwordx4 v[144:147], v1, s[28:31], s3 offen offset:256 nt
    s_barrier
    v_add_u32 v19, 1, v19
    buffer_store_dword v19, v18, s[48:51], s20 offen
    s_add_u32 m0, s85, 13312
    s_add_u32 s100, s90, 30720
    buffer_load_dwordx4 v2, s[36:39], s100 offen  lds
    s_waitcnt vmcnt(8)
    s_add_u32 s3, s80, 43008
    buffer_load_dwordx4 v[148:151], v1, s[28:31], s3 offen offset:0 nt
    buffer_load_dwordx4 v[152:155], v1, s[28:31], s3 offen offset:128 nt
    buffer_load_dwordx4 v[156:159], v1, s[28:31], s3 offen offset:256 nt
    s_barrier
    s_add_u32 m0, s85, 17408
    s_add_u32 s100, s90, 30848
    buffer_load_dwordx4 v2, s[36:39], s100 offen  lds
    s_waitcnt vmcnt(7)
    s_add_u32 s3, s80, 49152
    buffer_load_dwordx4 v[160:163], v1, s[28:31], s3 offen offset:0 nt
    buffer_load_dwordx4 v[164:167], v1, s[28:31], s3 offen offset:128 nt
    buffer_load_dwordx4 v[168:171], v1, s[28:31], s3 offen offset:256 nt
    s_barrier
    buffer_load_dwordx4 v[32:35], v6, s[48:51], 0 offen offset:0 sc1
    buffer_load_dwordx4 v[36:39], v6, s[48:51], 0 offen offset:1536 sc1
    s_lshl_b32 s81, s72, 6
    v_add_u32 v15, s81, v0
    v_lshlrev_b32 v14, 4, v15
    v_lshlrev_b32 v15, 3, v15
    v_add_u32 v14, 137600, v14
    v_add_u32 v15, 141696, v15
    v_and_b32 v17, 7, v0
    v_lshlrev_b32 v17, 4, v17
    v_add_u32 v17, 141696, v17
    v_mov_b32 v7, 0xff800000
    s_add_u32 m0, s85, 19456
    s_add_u32 s100, s91, 10240
    buffer_load_dwordx4 v2, s[36:39], s100 offen  lds
    s_waitcnt vmcnt(8)
    s_add_u32 s3, s80, 55296
    buffer_load_dwordx4 v[172:175], v1, s[28:31], s3 offen offset:0 nt
    buffer_load_dwordx4 v[176:179], v1, s[28:31], s3 offen offset:128 nt
    buffer_load_dwordx4 v[180:183], v1, s[28:31], s3 offen offset:256 nt
    s_barrier
    v_add_u32 v19, 1, v19
    buffer_store_dword v19, v18, s[48:51], s20 offen
    buffer_load_dword v58, v57, s[48:51], s23 offen sc1
    s_add_u32 m0, s85, 20480
    s_add_u32 s100, s90, 40960
    buffer_load_dwordx4 v2, s[36:39], s100 offen  lds
    s_waitcnt vmcnt(10)
    s_add_u32 s3, s54, 61440
    buffer_load_dwordx4 v[184:187], v1, s[28:31], s3 offen offset:0 nt
    buffer_load_dwordx4 v[188:191], v1, s[28:31], s3 offen offset:128 nt
    buffer_load_dwordx4 v[192:195], v1, s[28:31], s3 offen offset:256 nt
    s_barrier
    s_add_u32 m0, s85, 24576
    s_add_u32 s100, s90, 41088
    buffer_load_dwordx4 v2, s[36:39], s100 offen  lds
    s_waitcnt vmcnt(8)
    s_add_u32 s3, s80, 133632
    buffer_load_dwordx4 v[196:199], v1, s[28:31], s3 offen offset:0 nt
    buffer_load_dwordx4 v[200:203], v1, s[28:31], s3 offen offset:128 nt
    buffer_load_dwordx4 v[204:207], v1, s[28:31], s3 offen offset:256 nt
    s_barrier
    v_xor_b32 v8, s60, v32
    v_bitop3_b32 v8, v33, v8, s60 bitop3:0xde
    v_bitop3_b32 v8, v34, v8, s60 bitop3:0xde
    v_bitop3_b32 v8, v35, v8, s60 bitop3:0xde
    v_bitop3_b32 v8, v36, v8, s60 bitop3:0xde
    v_bitop3_b32 v8, v37, v8, s60 bitop3:0xde
    v_bitop3_b32 v8, v38, v8, s60 bitop3:0xde
    v_bitop3_b32 v8, v39, v8, s60 bitop3:0xde
    v_and_b32 v8, 7, v8
    v_cmp_ne_u32 vcc, 0, v8
    s_nop 1
    s_and_b64 vcc, vcc, s[62:63]
    s_cbranch_vccnz L_fb_ep
L_fb_ep_ret:
    v_and_b32 v32, -8, v32
    v_and_b32 v33, -8, v33
    v_and_b32 v34, -8, v34
    v_and_b32 v35, -8, v35
    v_and_b32 v36, -8, v36
    v_and_b32 v37, -8, v37
    v_and_b32 v38, -8, v38
    v_and_b32 v39, -8, v39
    v_pk_add_f32 v[32:33], v[32:33], v[36:37]
    v_pk_add_f32 v[34:35], v[34:35], v[38:39]
    v_cvt_pk_bf16_f32 v8, v32, v33
    v_cvt_pk_bf16_f32 v9, v34, v35
    ds_write_b128 v14, v[32:35]
    ds_write_b64 v15, v[8:9]
    s_add_u32 m0, s85, 21504
    s_add_u32 s100, s90, 51200
    buffer_load_dwordx4 v2, s[36:39], s100 offen  lds
    s_lshl2_add_u32 s81, s72, 143744
    v_mov_b32 v8, s81
    v_mov_b32 v9, 1
    v_mov_b32 v12, 143744
    s_waitcnt lgkmcnt(0)
    ds_write_b32 v8, v9
    s_add_u32 m0, s85, 25600
    s_add_u32 s100, s90, 51328
    buffer_load_dwordx4 v2, s[36:39], s100 offen  lds
    s_waitcnt vmcnt(7)
    s_add_u32 s3, s80, 139776
    buffer_load_dwordx4 v[208:211], v1, s[28:31], s3 offen offset:0 nt
    buffer_load_dwordx4 v[212:215], v1, s[28:31], s3 offen offset:128 nt
    buffer_load_dwordx4 v[216:219], v1, s[28:31], s3 offen offset:256 nt
    s_barrier
    v_add_u32 v19, 1, v19
    buffer_store_dword v19, v18, s[48:51], s20 offen
    s_add_u32 s24, s0, 1
    v_subrev_u32 v58, s24, v58
    v_cmp_gt_u32 s[68:69], 64, v58
    s_xor_b32 s24, s21, 3
    s_bitcmp1_b32 s68, s24
    s_cbranch_scc1 L_nh0_0
    s_xor_b32 s24, s25, 257
    s_mul_i32 s24, s24, 393216
    s_add_u32 s24, s24, 139776
    buffer_load_dword a240, v16, s[28:31], s24 offen nt
    buffer_load_dword a240, v16, s[28:31], s24 offen
    s_branch L_nh0
L_nh0_0:
    s_xor_b32 s24, s21, 16
    s_bitcmp1_b32 s68, s24
    s_cbranch_scc1 L_nh0_1
    s_xor_b32 s24, s25, 160
    s_mul_i32 s24, s24, 393216
    s_add_u32 s24, s24, 145920
    buffer_load_dword a240, v16, s[28:31], s24 offen nt
    buffer_load_dword a240, v16, s[28:31], s24 offen
    s_branch L_nh0
L_nh0_1:
    s_xor_b32 s24, s21, 9
    s_bitcmp1_b32 s68, s24
    s_cbranch_scc1 L_nh0
    s_xor_b32 s24, s25, 81
    s_mul_i32 s24, s24, 393216
    s_add_u32 s24, s24, 152064
    buffer_load_dword a240, v16, s[28:31], s24 offen nt
    buffer_load_dword a240, v16, s[28:31], s24 offen
L_nh0:
    buffer_load_dword v59, v57, s[48:51], s23 offen sc1
    ds_read_b128 v[8:11], v12
    ds_read_b128 v[20:23], v17 offset:0
    ds_read_b128 v[24:27], v17 offset:128
    ds_read_b128 v[28:31], v17 offset:256
    s_add_u32 m0, s85, 28672
    s_add_u32 s100, s91, 40960
    buffer_load_dwordx4 v2, s[36:39], s100 offen  lds
    s_waitcnt lgkmcnt(0)
    v_and_b32 v8, v8, v9
    v_and_b32 v10, v10, v11
    v_and_b32 v8, v8, v10
    v_cmp_ne_u32 vcc, 1, v8
    s_nop 1
    s_cbranch_vccnz L_fb_q
L_fb_q_ret:
    s_cmp_eq_u32 s72, 3
    s_cselect_b32 s81, 64512, 0
    v_lshrrev_b32 v8, 5, v0
    v_mul_u32_u24 v8, s81, v8
    v_sub_u32 v17, v1, v8
    v_and_b32 v15, 31, v0
    v_lshlrev_b32 v15, 2, v15
    v_mov_b32 v8, 0
    v_mov_b32 v9, 0
    v_dot2c_f32_bf16 v8, v64, v20
    v_dot2c_f32_bf16 v9, v76, v20
    v_dot2c_f32_bf16 v8, v65, v21
    v_dot2c_f32_bf16 v9, v77, v21
    v_dot2c_f32_bf16 v8, v66, v22
    v_dot2c_f32_bf16 v9, v78, v22
    v_dot2c_f32_bf16 v8, v67, v23
    v_dot2c_f32_bf16 v9, v79, v23
    v_dot2c_f32_bf16 v8, v68, v24
    v_dot2c_f32_bf16 v9, v80, v24
    v_dot2c_f32_bf16 v8, v69, v25
    v_dot2c_f32_bf16 v9, v81, v25
    v_dot2c_f32_bf16 v8, v70, v26
    v_dot2c_f32_bf16 v9, v82, v26
    v_dot2c_f32_bf16 v8, v71, v27
    v_dot2c_f32_bf16 v9, v83, v27
    v_dot2c_f32_bf16 v8, v72, v28
    v_dot2c_f32_bf16 v9, v84, v28
    v_dot2c_f32_bf16 v8, v73, v29
    v_dot2c_f32_bf16 v9, v85, v29
    v_dot2c_f32_bf16 v8, v74, v30
    v_dot2c_f32_bf16 v9, v86, v30
    v_dot2c_f32_bf16 v8, v75, v31
    v_dot2c_f32_bf16 v9, v87, v31
    s_nop 1
    v_add_f32_dpp v8, v8, v8 quad_perm:[1,0,3,2] row_mask:0xf bank_mask:0xf
    v_add_f32_dpp v9, v9, v9 quad_perm:[1,0,3,2] row_mask:0xf bank_mask:0xf
    s_nop 0
    v_add_f32_dpp v8, v8, v8 quad_perm:[2,3,0,1] row_mask:0xf bank_mask:0xf
    v_add_f32_dpp v9, v9, v9 quad_perm:[2,3,0,1] row_mask:0xf bank_mask:0xf
    s_nop 0
    v_add_f32_dpp v8, v8, v8 row_half_mirror row_mask:0xf bank_mask:0xf
    v_add_f32_dpp v9, v9, v9 row_half_mirror row_mask:0xf bank_mask:0xf
    v_cvt_pk_bf16_f32 v10, v8, v9
    v_lshlrev_b32 v8, 16, v10
    v_and_b32 v9, 0xffff0000, v10
    v_mul_f32 v8, 0x3d93cd3a, v8
    v_mul_f32 v9, 0x3d93cd3a, v9
    v_cvt_pk_bf16_f32 v10, v8, v9
    v_lshlrev_b32 v32, 16, v10
    v_and_b32 v33, 0xffff0000, v10
    v_max3_f32 v7, v7, v32, v33
    s_waitcnt vmcnt(9)
    s_add_u32 s3, s80, 145920
    buffer_load_dwordx4 v[220:223], v1, s[28:31], s3 offen offset:0 nt
    buffer_load_dwordx4 v[224:227], v1, s[28:31], s3 offen offset:128 nt
    buffer_load_dwordx4 v[228:231], v1, s[28:31], s3 offen offset:256 nt
    s_barrier
    v_mov_b32 v8, 0
    v_mov_b32 v9, 0
    v_dot2c_f32_bf16 v8, v88, v20
    v_dot2c_f32_bf16 v9, v100, v20
    v_dot2c_f32_bf16 v8, v89, v21
    v_dot2c_f32_bf16 v9, v101, v21
    v_dot2c_f32_bf16 v8, v90, v22
    v_dot2c_f32_bf16 v9, v102, v22
    v_dot2c_f32_bf16 v8, v91, v23
    v_dot2c_f32_bf16 v9, v103, v23
    v_dot2c_f32_bf16 v8, v92, v24
    v_dot2c_f32_bf16 v9, v104, v24
    v_dot2c_f32_bf16 v8, v93, v25
    v_dot2c_f32_bf16 v9, v105, v25
    v_dot2c_f32_bf16 v8, v94, v26
    v_dot2c_f32_bf16 v9, v106, v26
    v_dot2c_f32_bf16 v8, v95, v27
    v_dot2c_f32_bf16 v9, v107, v27
    v_dot2c_f32_bf16 v8, v96, v28
    v_dot2c_f32_bf16 v9, v108, v28
    v_dot2c_f32_bf16 v8, v97, v29
    v_dot2c_f32_bf16 v9, v109, v29
    v_dot2c_f32_bf16 v8, v98, v30
    v_dot2c_f32_bf16 v9, v110, v30
    v_dot2c_f32_bf16 v8, v99, v31
    v_dot2c_f32_bf16 v9, v111, v31
    s_nop 1
    v_add_f32_dpp v8, v8, v8 quad_perm:[1,0,3,2] row_mask:0xf bank_mask:0xf
    v_add_f32_dpp v9, v9, v9 quad_perm:[1,0,3,2] row_mask:0xf bank_mask:0xf
    s_nop 0
    v_add_f32_dpp v8, v8, v8 quad_perm:[2,3,0,1] row_mask:0xf bank_mask:0xf
    v_add_f32_dpp v9, v9, v9 quad_perm:[2,3,0,1] row_mask:0xf bank_mask:0xf
    s_nop 0
    v_add_f32_dpp v8, v8, v8 row_half_mirror row_mask:0xf bank_mask:0xf
    v_add_f32_dpp v9, v9, v9 row_half_mirror row_mask:0xf bank_mask:0xf
    v_cvt_pk_bf16_f32 v10, v8, v9
    v_lshlrev_b32 v8, 16, v10
    v_and_b32 v9, 0xffff0000, v10
    v_mul_f32 v8, 0x3d93cd3a, v8
    v_mul_f32 v9, 0x3d93cd3a, v9
    v_cvt_pk_bf16_f32 v10, v8, v9
    v_lshlrev_b32 v34, 16, v10
    v_and_b32 v35, 0xffff0000, v10
    v_max3_f32 v7, v7, v34, v35
    s_add_u32 m0, s85, 22528
    s_add_u32 s100, s90, 61440
    buffer_load_dwordx4 v2, s[36:39], s100 offen  lds
    v_mov_b32 v8, 0
    v_mov_b32 v9, 0
    v_dot2c_f32_bf16 v8, v112, v20
    v_dot2c_f32_bf16 v9, v124, v20
    v_dot2c_f32_bf16 v8, v113, v21
    v_dot2c_f32_bf16 v9, v125, v21
    v_dot2c_f32_bf16 v8, v114, v22
    v_dot2c_f32_bf16 v9, v126, v22
    v_dot2c_f32_bf16 v8, v115, v23
    v_dot2c_f32_bf16 v9, v127, v23
    v_dot2c_f32_bf16 v8, v116, v24
    v_dot2c_f32_bf16 v9, v128, v24
    v_dot2c_f32_bf16 v8, v117, v25
    v_dot2c_f32_bf16 v9, v129, v25
    v_dot2c_f32_bf16 v8, v118, v26
    v_dot2c_f32_bf16 v9, v130, v26
    v_dot2c_f32_bf16 v8, v119, v27
    v_dot2c_f32_bf16 v9, v131, v27
    v_dot2c_f32_bf16 v8, v120, v28
    v_dot2c_f32_bf16 v9, v132, v28
    v_dot2c_f32_bf16 v8, v121, v29
    v_dot2c_f32_bf16 v9, v133, v29
    v_dot2c_f32_bf16 v8, v122, v30
    v_dot2c_f32_bf16 v9, v134, v30
    v_dot2c_f32_bf16 v8, v123, v31
    v_dot2c_f32_bf16 v9, v135, v31
    s_nop 1
    v_add_f32_dpp v8, v8, v8 quad_perm:[1,0,3,2] row_mask:0xf bank_mask:0xf
    v_add_f32_dpp v9, v9, v9 quad_perm:[1,0,3,2] row_mask:0xf bank_mask:0xf
    s_nop 0
    v_add_f32_dpp v8, v8, v8 quad_perm:[2,3,0,1] row_mask:0xf bank_mask:0xf
    v_add_f32_dpp v9, v9, v9 quad_perm:[2,3,0,1] row_mask:0xf bank_mask:0xf
    s_nop 0
    v_add_f32_dpp v8, v8, v8 row_half_mirror row_mask:0xf bank_mask:0xf
    v_add_f32_dpp v9, v9, v9 row_half_mirror row_mask:0xf bank_mask:0xf
    v_cvt_pk_bf16_f32 v10, v8, v9
    v_lshlrev_b32 v8, 16, v10
    v_and_b32 v9, 0xffff0000, v10
    v_mul_f32 v8, 0x3d93cd3a, v8
    v_mul_f32 v9, 0x3d93cd3a, v9
    v_cvt_pk_bf16_f32 v10, v8, v9
    v_lshlrev_b32 v36, 16, v10
    v_and_b32 v37, 0xffff0000, v10
    v_max3_f32 v7, v7, v36, v37
    s_waitcnt vmcnt(8)
    s_add_u32 s3, s80, 152064
    buffer_load_dwordx4 v[232:235], v1, s[28:31], s3 offen offset:0 nt
    buffer_load_dwordx4 v[236:239], v1, s[28:31], s3 offen offset:128 nt
    buffer_load_dwordx4 v[240:243], v1, s[28:31], s3 offen offset:256 nt
    s_barrier
    v_mov_b32 v8, 0
    v_mov_b32 v9, 0
    v_dot2c_f32_bf16 v8, v136, v20
    v_dot2c_f32_bf16 v9, v148, v20
    v_dot2c_f32_bf16 v8, v137, v21
    v_dot2c_f32_bf16 v9, v149, v21
    v_dot2c_f32_bf16 v8, v138, v22
    v_dot2c_f32_bf16 v9, v150, v22
    v_dot2c_f32_bf16 v8, v139, v23
    v_dot2c_f32_bf16 v9, v151, v23
    v_dot2c_f32_bf16 v8, v140, v24
    v_dot2c_f32_bf16 v9, v152, v24
    v_dot2c_f32_bf16 v8, v141, v25
    v_dot2c_f32_bf16 v9, v153, v25
    v_dot2c_f32_bf16 v8, v142, v26
    v_dot2c_f32_bf16 v9, v154, v26
    v_dot2c_f32_bf16 v8, v143, v27
    v_dot2c_f32_bf16 v9, v155, v27
    v_dot2c_f32_bf16 v8, v144, v28
    v_dot2c_f32_bf16 v9, v156, v28
    v_dot2c_f32_bf16 v8, v145, v29
    v_dot2c_f32_bf16 v9, v157, v29
    v_dot2c_f32_bf16 v8, v146, v30
    v_dot2c_f32_bf16 v9, v158, v30
    v_dot2c_f32_bf16 v8, v147, v31
    v_dot2c_f32_bf16 v9, v159, v31
    s_nop 1
    v_add_f32_dpp v8, v8, v8 quad_perm:[1,0,3,2] row_mask:0xf bank_mask:0xf
    v_add_f32_dpp v9, v9, v9 quad_perm:[1,0,3,2] row_mask:0xf bank_mask:0xf
    s_nop 0
    v_add_f32_dpp v8, v8, v8 quad_perm:[2,3,0,1] row_mask:0xf bank_mask:0xf
    v_add_f32_dpp v9, v9, v9 quad_perm:[2,3,0,1] row_mask:0xf bank_mask:0xf
    s_nop 0
    v_add_f32_dpp v8, v8, v8 row_half_mirror row_mask:0xf bank_mask:0xf
    v_add_f32_dpp v9, v9, v9 row_half_mirror row_mask:0xf bank_mask:0xf
    v_cvt_pk_bf16_f32 v10, v8, v9
    v_lshlrev_b32 v8, 16, v10
    v_and_b32 v9, 0xffff0000, v10
    v_mul_f32 v8, 0x3d93cd3a, v8
    v_mul_f32 v9, 0x3d93cd3a, v9
    v_cvt_pk_bf16_f32 v10, v8, v9
    v_lshlrev_b32 v38, 16, v10
    v_and_b32 v39, 0xffff0000, v10
    v_max3_f32 v7, v7, v38, v39
    s_add_u32 m0, s85, 26624
    s_add_u32 s100, s90, 61568
    buffer_load_dwordx4 v2, s[36:39], s100 offen  lds
    v_mov_b32 v8, 0
    v_mov_b32 v9, 0
    v_dot2c_f32_bf16 v8, v160, v20
    v_dot2c_f32_bf16 v9, v172, v20
    v_dot2c_f32_bf16 v8, v161, v21
    v_dot2c_f32_bf16 v9, v173, v21
    v_dot2c_f32_bf16 v8, v162, v22
    v_dot2c_f32_bf16 v9, v174, v22
    v_dot2c_f32_bf16 v8, v163, v23
    v_dot2c_f32_bf16 v9, v175, v23
    v_dot2c_f32_bf16 v8, v164, v24
    v_dot2c_f32_bf16 v9, v176, v24
    v_dot2c_f32_bf16 v8, v165, v25
    v_dot2c_f32_bf16 v9, v177, v25
    v_dot2c_f32_bf16 v8, v166, v26
    v_dot2c_f32_bf16 v9, v178, v26
    v_dot2c_f32_bf16 v8, v167, v27
    v_dot2c_f32_bf16 v9, v179, v27
    v_dot2c_f32_bf16 v8, v168, v28
    v_dot2c_f32_bf16 v9, v180, v28
    v_dot2c_f32_bf16 v8, v169, v29
    v_dot2c_f32_bf16 v9, v181, v29
    v_dot2c_f32_bf16 v8, v170, v30
    v_dot2c_f32_bf16 v9, v182, v30
    v_dot2c_f32_bf16 v8, v171, v31
    v_dot2c_f32_bf16 v9, v183, v31
    s_nop 1
    v_add_f32_dpp v8, v8, v8 quad_perm:[1,0,3,2] row_mask:0xf bank_mask:0xf
    v_add_f32_dpp v9, v9, v9 quad_perm:[1,0,3,2] row_mask:0xf bank_mask:0xf
    s_nop 0
    v_add_f32_dpp v8, v8, v8 quad_perm:[2,3,0,1] row_mask:0xf bank_mask:0xf
    v_add_f32_dpp v9, v9, v9 quad_perm:[2,3,0,1] row_mask:0xf bank_mask:0xf
    s_nop 0
    v_add_f32_dpp v8, v8, v8 row_half_mirror row_mask:0xf bank_mask:0xf
    v_add_f32_dpp v9, v9, v9 row_half_mirror row_mask:0xf bank_mask:0xf
    v_cvt_pk_bf16_f32 v10, v8, v9
    v_lshlrev_b32 v8, 16, v10
    v_and_b32 v9, 0xffff0000, v10
    v_mul_f32 v8, 0x3d93cd3a, v8
    v_mul_f32 v9, 0x3d93cd3a, v9
    v_cvt_pk_bf16_f32 v10, v8, v9
    v_lshlrev_b32 v40, 16, v10
    v_and_b32 v41, 0xffff0000, v10
    v_max3_f32 v7, v7, v40, v41
    s_waitcnt vmcnt(6)
    s_add_u32 s3, s80, 158208
    buffer_load_dwordx4 v[244:247], v1, s[28:31], s3 offen offset:0 nt
    buffer_load_dwordx4 v[248:251], v1, s[28:31], s3 offen offset:128 nt
    buffer_load_dwordx4 v[252:255], v1, s[28:31], s3 offen offset:256 nt
    s_barrier
    v_add_u32 v19, 1, v19
    buffer_store_dword v19, v18, s[48:51], s20 offen
    s_add_u32 s24, s0, 2
    v_subrev_u32 v59, s24, v59
    v_cmp_gt_u32 s[68:69], 64, v59
    s_xor_b32 s24, s21, 8
    s_bitcmp1_b32 s68, s24
    s_cbranch_scc1 L_nh1_0
    s_xor_b32 s24, s25, 80
    s_mul_i32 s24, s24, 393216
    s_add_u32 s24, s24, 158208
    buffer_load_dword a240, v16, s[28:31], s24 offen nt
    buffer_load_dword a240, v16, s[28:31], s24 offen
    s_branch L_nh1
L_nh1_0:
    s_xor_b32 s24, s21, 5
    s_bitcmp1_b32 s68, s24
    s_cbranch_scc1 L_nh1_1
    s_xor_b32 s24, s25, 513
    s_mul_i32 s24, s24, 393216
    s_add_u32 s24, s24, 164352
    buffer_load_dword a240, v16, s[28:31], s24 offen nt
    buffer_load_dword a240, v16, s[28:31], s24 offen
    s_branch L_nh1
L_nh1_1:
    s_xor_b32 s24, s21, 4
    s_bitcmp1_b32 s68, s24
    s_cbranch_scc1 L_nh1
    s_xor_b32 s24, s25, 512
    s_mul_i32 s24, s24, 393216
    s_add_u32 s24, s24, 170496
    buffer_load_dword a240, v16, s[28:31], s24 offen nt
    buffer_load_dword a240, v16, s[28:31], s24 offen
L_nh1:
    buffer_load_dword v6, v15, s[48:51], s23 offen sc1
    v_mov_b32 v8, 0
    v_mov_b32 v9, 0
    v_dot2c_f32_bf16 v8, v184, v20
    v_dot2c_f32_bf16 v9, v196, v20
    v_dot2c_f32_bf16 v8, v185, v21
    v_dot2c_f32_bf16 v9, v197, v21
    v_dot2c_f32_bf16 v8, v186, v22
    v_dot2c_f32_bf16 v9, v198, v22
    v_dot2c_f32_bf16 v8, v187, v23
    v_dot2c_f32_bf16 v9, v199, v23
    v_dot2c_f32_bf16 v8, v188, v24
    v_dot2c_f32_bf16 v9, v200, v24
    v_dot2c_f32_bf16 v8, v189, v25
    v_dot2c_f32_bf16 v9, v201, v25
    v_dot2c_f32_bf16 v8, v190, v26
    v_dot2c_f32_bf16 v9, v202, v26
    v_dot2c_f32_bf16 v8, v191, v27
    v_dot2c_f32_bf16 v9, v203, v27
    v_dot2c_f32_bf16 v8, v192, v28
    v_dot2c_f32_bf16 v9, v204, v28
    v_dot2c_f32_bf16 v8, v193, v29
    v_dot2c_f32_bf16 v9, v205, v29
    v_dot2c_f32_bf16 v8, v194, v30
    v_dot2c_f32_bf16 v9, v206, v30
    v_dot2c_f32_bf16 v8, v195, v31
    v_dot2c_f32_bf16 v9, v207, v31
    s_nop 1
    v_add_f32_dpp v8, v8, v8 quad_perm:[1,0,3,2] row_mask:0xf bank_mask:0xf
    v_add_f32_dpp v9, v9, v9 quad_perm:[1,0,3,2] row_mask:0xf bank_mask:0xf
    s_nop 0
    v_add_f32_dpp v8, v8, v8 quad_perm:[2,3,0,1] row_mask:0xf bank_mask:0xf
    v_add_f32_dpp v9, v9, v9 quad_perm:[2,3,0,1] row_mask:0xf bank_mask:0xf
    s_nop 0
    v_add_f32_dpp v8, v8, v8 row_half_mirror row_mask:0xf bank_mask:0xf
    v_add_f32_dpp v9, v9, v9 row_half_mirror row_mask:0xf bank_mask:0xf
    v_cvt_pk_bf16_f32 v10, v8, v9
    v_lshlrev_b32 v8, 16, v10
    v_and_b32 v9, 0xffff0000, v10
    v_mul_f32 v8, 0x3d93cd3a, v8
    v_mul_f32 v9, 0x3d93cd3a, v9
    v_cvt_pk_bf16_f32 v10, v8, v9
    v_lshlrev_b32 v42, 16, v10
    v_and_b32 v43, 0xffff0000, v10
    v_max3_f32 v7, v7, v42, v43
    s_add_u32 m0, s85, 23552
    s_add_u32 s100, s90, 71680
    buffer_load_dwordx4 v2, s[36:39], s100 offen  lds
    v_xor_b32 v8, 4, v3
    v_mov_b32 v9, 1
    ds_write_b32 v8, v9
    ds_read_b64_tr_b16 a[0:1], v4 offset:10240
    ds_read_b64_tr_b16 a[2:3], v4 offset:10752
    ds_read_b64_tr_b16 a[4:5], v4 offset:10272
    ds_read_b64_tr_b16 a[6:7], v4 offset:10784
    ds_read_b64_tr_b16 a[8:9], v4 offset:10304
    ds_read_b64_tr_b16 a[10:11], v4 offset:10816
    s_waitcnt vmcnt(8)
    s_add_u32 s3, s80, 164352
    buffer_load_dwordx4 v[64:67], v1, s[28:31], s3 offen offset:0 nt
    buffer_load_dwordx4 v[68:71], v1, s[28:31], s3 offen offset:128 nt
    buffer_load_dwordx4 v[72:75], v1, s[28:31], s3 offen offset:256 nt
    s_barrier
    ds_read_b64_tr_b16 a[12:13], v4 offset:10336
    ds_read_b64_tr_b16 a[14:15], v4 offset:10848
    ds_read_b64_tr_b16 a[16:17], v4 offset:14336
    ds_read_b64_tr_b16 a[18:19], v4 offset:14848
    ds_read_b64_tr_b16 a[20:21], v4 offset:14368
    ds_read_b64_tr_b16 a[22:23], v4 offset:14880
    s_add_u32 m0, s85, 27648
    s_add_u32 s100, s90, 71808
    buffer_load_dwordx4 v2, s[36:39], s100 offen  lds
    ds_read_b64_tr_b16 a[24:25], v4 offset:14400
    ds_read_b64_tr_b16 a[26:27], v4 offset:14912
    ds_read_b64_tr_b16 a[28:29], v4 offset:14432
    ds_read_b64_tr_b16 a[30:31], v4 offset:14944
    s_add_u32 m0, s85, 29696
    s_add_u32 s100, s91, 51200
    buffer_load_dwordx4 v2, s[36:39], s100 offen  lds
    ds_read_b32 v8, v3
    s_waitcnt vmcnt(9)
    s_add_u32 s3, s80, 170496
    buffer_load_dwordx4 v[76:79], v1, s[28:31], s3 offen offset:0 nt
    buffer_load_dwordx4 v[80:83], v1, s[28:31], s3 offen offset:128 nt
    buffer_load_dwordx4 v[84:87], v1, s[28:31], s3 offen offset:256 nt
    s_barrier
    s_waitcnt lgkmcnt(0)
    v_cmp_gt_u32 vcc, 1, v8
    s_nop 1
    s_cbranch_vccnz L_fb_h0
L_fb_h0_ret:
    ds_read_b64_tr_b16 a[32:33], v5 offset:18432
    ds_read_b64_tr_b16 a[34:35], v5 offset:18944
    s_add_u32 m0, s85, 0
    s_add_u32 s100, s90, 81920
    buffer_load_dwordx4 v2, s[36:39], s100 offen  lds
    ds_read_b64_tr_b16 a[36:37], v5 offset:18464
    ds_read_b64_tr_b16 a[38:39], v5 offset:18976
    v_mov_b32 v8, 0
    v_mov_b32 v9, 0
    v_dot2c_f32_bf16 v8, v208, v20
    v_dot2c_f32_bf16 v9, v220, v20
    v_dot2c_f32_bf16 v8, v209, v21
    v_dot2c_f32_bf16 v9, v221, v21
    v_dot2c_f32_bf16 v8, v210, v22
    v_dot2c_f32_bf16 v9, v222, v22
    v_dot2c_f32_bf16 v8, v211, v23
    v_dot2c_f32_bf16 v9, v223, v23
    v_dot2c_f32_bf16 v8, v212, v24
    v_dot2c_f32_bf16 v9, v224, v24
    v_dot2c_f32_bf16 v8, v213, v25
    v_dot2c_f32_bf16 v9, v225, v25
    v_dot2c_f32_bf16 v8, v214, v26
    v_dot2c_f32_bf16 v9, v226, v26
    v_dot2c_f32_bf16 v8, v215, v27
    v_dot2c_f32_bf16 v9, v227, v27
    v_dot2c_f32_bf16 v8, v216, v28
    v_dot2c_f32_bf16 v9, v228, v28
    v_dot2c_f32_bf16 v8, v217, v29
    v_dot2c_f32_bf16 v9, v229, v29
    v_dot2c_f32_bf16 v8, v218, v30
    v_dot2c_f32_bf16 v9, v230, v30
    v_dot2c_f32_bf16 v8, v219, v31
    v_dot2c_f32_bf16 v9, v231, v31
    s_nop 1
    v_add_f32_dpp v8, v8, v8 quad_perm:[1,0,3,2] row_mask:0xf bank_mask:0xf
    v_add_f32_dpp v9, v9, v9 quad_perm:[1,0,3,2] row_mask:0xf bank_mask:0xf
    s_nop 0
    v_add_f32_dpp v8, v8, v8 quad_perm:[2,3,0,1] row_mask:0xf bank_mask:0xf
    v_add_f32_dpp v9, v9, v9 quad_perm:[2,3,0,1] row_mask:0xf bank_mask:0xf
    s_nop 0
    v_add_f32_dpp v8, v8, v8 row_half_mirror row_mask:0xf bank_mask:0xf
    v_add_f32_dpp v9, v9, v9 row_half_mirror row_mask:0xf bank_mask:0xf
    v_cvt_pk_bf16_f32 v10, v8, v9
    v_lshlrev_b32 v8, 16, v10
    v_and_b32 v9, 0xffff0000, v10
    v_mul_f32 v8, 0x3d93cd3a, v8
    v_mul_f32 v9, 0x3d93cd3a, v9
    v_cvt_pk_bf16_f32 v10, v8, v9
    v_lshlrev_b32 v44, 16, v10
    v_and_b32 v45, 0xffff0000, v10
    v_max3_f32 v7, v7, v44, v45
    s_waitcnt vmcnt(7)
    s_add_u32 s3, s80, 176640
    buffer_load_dwordx4 v[88:91], v1, s[28:31], s3 offen offset:0 nt
    buffer_load_dwordx4 v[92:95], v1, s[28:31], s3 offen offset:128 nt
    buffer_load_dwordx4 v[96:99], v1, s[28:31], s3 offen offset:256 nt
    s_barrier
    v_add_u32 v19, 1, v19
    buffer_store_dword v19, v18, s[48:51], s20 offen
    s_add_u32 s24, s0, 3
    v_subrev_u32 v6, s24, v6
    v_cmp_gt_u32 s[68:69], 64, v6
    s_xor_b32 s24, s21, 18
    s_bitcmp1_b32 s68, s24
    s_cbranch_scc1 L_nh2_0
    s_xor_b32 s24, s25, 416
    s_mul_i32 s24, s24, 393216
    s_add_u32 s24, s24, 176640
    buffer_load_dword a240, v16, s[28:31], s24 offen nt
    buffer_load_dword a240, v16, s[28:31], s24 offen
    s_branch L_nh2
L_nh2_0:
    s_xor_b32 s24, s21, 2
    s_bitcmp1_b32 s68, s24
    s_cbranch_scc1 L_nh2_1
    s_xor_b32 s24, s25, 256
    s_mul_i32 s24, s24, 393216
    s_add_u32 s24, s24, 182784
    buffer_load_dword a240, v16, s[28:31], s24 offen nt
    buffer_load_dword a240, v16, s[28:31], s24 offen
    s_branch L_nh2
L_nh2_1:
    s_xor_b32 s24, s21, 28
    s_bitcmp1_b32 s68, s24
    s_cbranch_scc1 L_nh2
    s_xor_b32 s24, s25, 752
    s_mul_i32 s24, s24, 393216
    s_add_u32 s24, s24, 188928
    buffer_load_dword a240, v16, s[28:31], s24 offen nt
    buffer_load_dword a240, v16, s[28:31], s24 offen
L_nh2:
    buffer_load_dword v14, v15, s[48:51], s23 offen sc1
    v_mov_b32 v8, 0
    v_mov_b32 v9, 0
    v_dot2c_f32_bf16 v8, v232, v20
    v_dot2c_f32_bf16 v9, v244, v20
    v_dot2c_f32_bf16 v8, v233, v21
    v_dot2c_f32_bf16 v9, v245, v21
    v_dot2c_f32_bf16 v8, v234, v22
    v_dot2c_f32_bf16 v9, v246, v22
    v_dot2c_f32_bf16 v8, v235, v23
    v_dot2c_f32_bf16 v9, v247, v23
    v_dot2c_f32_bf16 v8, v236, v24
    v_dot2c_f32_bf16 v9, v248, v24
    v_dot2c_f32_bf16 v8, v237, v25
    v_dot2c_f32_bf16 v9, v249, v25
    v_dot2c_f32_bf16 v8, v238, v26
    v_dot2c_f32_bf16 v9, v250, v26
    v_dot2c_f32_bf16 v8, v239, v27
    v_dot2c_f32_bf16 v9, v251, v27
    v_dot2c_f32_bf16 v8, v240, v28
    v_dot2c_f32_bf16 v9, v252, v28
    v_dot2c_f32_bf16 v8, v241, v29
    v_dot2c_f32_bf16 v9, v253, v29
    v_dot2c_f32_bf16 v8, v242, v30
    v_dot2c_f32_bf16 v9, v254, v30
    v_dot2c_f32_bf16 v8, v243, v31
    v_dot2c_f32_bf16 v9, v255, v31
    s_nop 1
    v_add_f32_dpp v8, v8, v8 quad_perm:[1,0,3,2] row_mask:0xf bank_mask:0xf
    v_add_f32_dpp v9, v9, v9 quad_perm:[1,0,3,2] row_mask:0xf bank_mask:0xf
    s_nop 0
    v_add_f32_dpp v8, v8, v8 quad_perm:[2,3,0,1] row_mask:0xf bank_mask:0xf
    v_add_f32_dpp v9, v9, v9 quad_perm:[2,3,0,1] row_mask:0xf bank_mask:0xf
    s_nop 0
    v_add_f32_dpp v8, v8, v8 row_half_mirror row_mask:0xf bank_mask:0xf
    v_add_f32_dpp v9, v9, v9 row_half_mirror row_mask:0xf bank_mask:0xf
    v_cvt_pk_bf16_f32 v10, v8, v9
    v_lshlrev_b32 v8, 16, v10
    v_and_b32 v9, 0xffff0000, v10
    v_mul_f32 v8, 0x3d93cd3a, v8
    v_mul_f32 v9, 0x3d93cd3a, v9
    v_cvt_pk_bf16_f32 v10, v8, v9
    v_lshlrev_b32 v46, 16, v10
    v_and_b32 v47, 0xffff0000, v10
    v_max3_f32 v7, v7, v46, v47
    s_add_u32 m0, s85, 4096
    s_add_u32 s100, s90, 82048
    buffer_load_dwordx4 v2, s[36:39], s100 offen  lds
    s_waitcnt vmcnt(8)
    s_add_u32 s3, s80, 182784
    buffer_load_dwordx4 v[100:103], v1, s[28:31], s3 offen offset:0 nt
    buffer_load_dwordx4 v[104:107], v1, s[28:31], s3 offen offset:128 nt
    buffer_load_dwordx4 v[108:111], v1, s[28:31], s3 offen offset:256 nt
    s_barrier
    s_waitcnt lgkmcnt(0)
    v_xor_b32 v8, 4, v3
    v_mov_b32 v9, 2
    ds_write_b32 v8, v9
    ds_read_b64_tr_b16 a[40:41], v4 offset:20480
    ds_read_b64_tr_b16 a[42:43], v4 offset:20992
    ds_read_b64_tr_b16 a[44:45], v4 offset:20512
    ds_read_b64_tr_b16 a[46:47], v4 offset:21024
    ds_read_b64_tr_b16 a[48:49], v4 offset:20544
    ds_read_b64_tr_b16 a[50:51], v4 offset:21056
    s_add_u32 m0, s85, 1024
    s_add_u32 s100, s90, 92160
    buffer_load_dwordx4 v2, s[36:39], s100 offen  lds
    ds_read_b64_tr_b16 a[52:53], v4 offset:20576
    ds_read_b64_tr_b16 a[54:55], v4 offset:21088
    ds_read_b64_tr_b16 a[56:57], v4 offset:24576
    ds_read_b64_tr_b16 a[58:59], v4 offset:25088
    ds_read_b64_tr_b16 a[60:61], v4 offset:24608
    ds_read_b64_tr_b16 a[62:63], v4 offset:25120
    s_waitcnt vmcnt(8)
    s_add_u32 s3, s80, 188928
    buffer_load_dwordx4 v[112:115], v1, s[28:31], s3 offen offset:0 nt
    buffer_load_dwordx4 v[116:119], v1, s[28:31], s3 offen offset:128 nt
    buffer_load_dwordx4 v[120:123], v1, s[28:31], s3 offen offset:256 nt
    s_barrier
    ds_read_b64_tr_b16 a[64:65], v4 offset:24640
    ds_read_b64_tr_b16 a[66:67], v4 offset:25152
    ds_read_b64_tr_b16 a[68:69], v4 offset:24672
    ds_read_b64_tr_b16 a[70:71], v4 offset:25184
    s_add_u32 m0, s85, 5120
    s_add_u32 s100, s90, 92288
    buffer_load_dwordx4 v2, s[36:39], s100 offen  lds
    ds_read_b32 v8, v3
    s_waitcnt vmcnt(6)
    s_add_u32 s3, s55, 129024
    buffer_load_dwordx4 v[124:127], v1, s[28:31], s3 offen offset:0 nt
    buffer_load_dwordx4 v[128:131], v1, s[28:31], s3 offen offset:128 nt
    buffer_load_dwordx4 v[132:135], v1, s[28:31], s3 offen offset:256 nt
    s_barrier
    v_add_u32 v19, 1, v19
    buffer_store_dword v19, v18, s[48:51], s20 offen
    s_add_u32 s24, s0, 4
    v_subrev_u32 v14, s24, v14
    v_cmp_gt_u32 s[68:69], 64, v14
    s_xor_b32 s24, s21, 21
    s_bitcmp1_b32 s68, s24
    s_cbranch_scc1 L_nh3_0
    s_xor_b32 s24, s25, 673
    s_mul_i32 s24, s24, 393216
    s_sub_u32 s22, s55, s80
    s_add_u32 s24, s24, s22
    s_add_u32 s24, s24, 129024
    buffer_load_dword a240, v16, s[28:31], s24 offen nt
    buffer_load_dword a240, v16, s[28:31], s24 offen
    s_branch L_nh3
L_nh3_0:
    s_xor_b32 s24, s21, 10
    s_bitcmp1_b32 s68, s24
    s_cbranch_scc1 L_nh3_1
    s_xor_b32 s24, s25, 336
    s_mul_i32 s24, s24, 393216
    s_add_u32 s24, s24, 267264
    buffer_load_dword a240, v16, s[28:31], s24 offen nt
    buffer_load_dword a240, v16, s[28:31], s24 offen
    s_branch L_nh3
L_nh3_1:
    s_xor_b32 s24, s21, 7
    s_bitcmp1_b32 s68, s24
    s_cbranch_scc1 L_nh3
    s_xor_b32 s24, s25, 769
    s_mul_i32 s24, s24, 393216
    s_add_u32 s24, s24, 273408
    buffer_load_dword a240, v16, s[28:31], s24 offen nt
    buffer_load_dword a240, v16, s[28:31], s24 offen
L_nh3:
    buffer_load_dword v6, v15, s[48:51], s23 offen sc1
    s_waitcnt lgkmcnt(0)
    v_cmp_gt_u32 vcc, 2, v8
    s_nop 1
    s_cbranch_vccnz L_fb_h1
L_fb_h1_ret:
    ds_read_b64_tr_b16 a[72:73], v5 offset:28672
    ds_read_b64_tr_b16 a[74:75], v5 offset:29184
    s_add_u32 m0, s85, 8192
    s_add_u32 s100, s91, 81920
    buffer_load_dwordx4 v2, s[36:39], s100 offen  lds
    ds_read_b64_tr_b16 a[76:77], v5 offset:28704
    ds_read_b64_tr_b16 a[78:79], v5 offset:29216
    v_mov_b32 v8, 0
    v_mov_b32 v9, 0
    v_dot2c_f32_bf16 v8, v64, v20
    v_dot2c_f32_bf16 v9, v76, v20
    v_dot2c_f32_bf16 v8, v65, v21
    v_dot2c_f32_bf16 v9, v77, v21
    v_dot2c_f32_bf16 v8, v66, v22
    v_dot2c_f32_bf16 v9, v78, v22
    v_dot2c_f32_bf16 v8, v67, v23
    v_dot2c_f32_bf16 v9, v79, v23
    v_dot2c_f32_bf16 v8, v68, v24
    v_dot2c_f32_bf16 v9, v80, v24
    v_dot2c_f32_bf16 v8, v69, v25
    v_dot2c_f32_bf16 v9, v81, v25
    v_dot2c_f32_bf16 v8, v70, v26
    v_dot2c_f32_bf16 v9, v82, v26
    v_dot2c_f32_bf16 v8, v71, v27
    v_dot2c_f32_bf16 v9, v83, v27
    v_dot2c_f32_bf16 v8, v72, v28
    v_dot2c_f32_bf16 v9, v84, v28
    v_dot2c_f32_bf16 v8, v73, v29
    v_dot2c_f32_bf16 v9, v85, v29
    v_dot2c_f32_bf16 v8, v74, v30
    v_dot2c_f32_bf16 v9, v86, v30
    v_dot2c_f32_bf16 v8, v75, v31
    v_dot2c_f32_bf16 v9, v87, v31
    s_nop 1
    v_add_f32_dpp v8, v8, v8 quad_perm:[1,0,3,2] row_mask:0xf bank_mask:0xf
    v_add_f32_dpp v9, v9, v9 quad_perm:[1,0,3,2] row_mask:0xf bank_mask:0xf
    s_nop 0
    v_add_f32_dpp v8, v8, v8 quad_perm:[2,3,0,1] row_mask:0xf bank_mask:0xf
    v_add_f32_dpp v9, v9, v9 quad_perm:[2,3,0,1] row_mask:0xf bank_mask:0xf
    s_nop 0
    v_add_f32_dpp v8, v8, v8 row_half_mirror row_mask:0xf bank_mask:0xf
    v_add_f32_dpp v9, v9, v9 row_half_mirror row_mask:0xf bank_mask:0xf
    v_cvt_pk_bf16_f32 v10, v8, v9
    v_lshlrev_b32 v8, 16, v10
    v_and_b32 v9, 0xffff0000, v10
    v_mul_f32 v8, 0x3d93cd3a, v8
    v_mul_f32 v9, 0x3d93cd3a, v9
    v_cvt_pk_bf16_f32 v10, v8, v9
    v_lshlrev_b32 v48, 16, v10
    v_and_b32 v49, 0xffff0000, v10
    v_max3_f32 v7, v7, v48, v49
    s_waitcnt vmcnt(8)
    s_add_u32 s3, s80, 267264
    buffer_load_dwordx4 v[136:139], v1, s[28:31], s3 offen offset:0 nt
    buffer_load_dwordx4 v[140:143], v1, s[28:31], s3 offen offset:128 nt
    buffer_load_dwordx4 v[144:147], v1, s[28:31], s3 offen offset:256 nt
    s_barrier
    v_mov_b32 v8, 0
    v_mov_b32 v9, 0
    v_dot2c_f32_bf16 v8, v88, v20
    v_dot2c_f32_bf16 v9, v100, v20
    v_dot2c_f32_bf16 v8, v89, v21
    v_dot2c_f32_bf16 v9, v101, v21
    v_dot2c_f32_bf16 v8, v90, v22
    v_dot2c_f32_bf16 v9, v102, v22
    v_dot2c_f32_bf16 v8, v91, v23
    v_dot2c_f32_bf16 v9, v103, v23
    v_dot2c_f32_bf16 v8, v92, v24
    v_dot2c_f32_bf16 v9, v104, v24
    v_dot2c_f32_bf16 v8, v93, v25
    v_dot2c_f32_bf16 v9, v105, v25
    v_dot2c_f32_bf16 v8, v94, v26
    v_dot2c_f32_bf16 v9, v106, v26
    v_dot2c_f32_bf16 v8, v95, v27
    v_dot2c_f32_bf16 v9, v107, v27
    v_dot2c_f32_bf16 v8, v96, v28
    v_dot2c_f32_bf16 v9, v108, v28
    v_dot2c_f32_bf16 v8, v97, v29
    v_dot2c_f32_bf16 v9, v109, v29
    v_dot2c_f32_bf16 v8, v98, v30
    v_dot2c_f32_bf16 v9, v110, v30
    v_dot2c_f32_bf16 v8, v99, v31
    v_dot2c_f32_bf16 v9, v111, v31
    s_nop 1
    v_add_f32_dpp v8, v8, v8 quad_perm:[1,0,3,2] row_mask:0xf bank_mask:0xf
    v_add_f32_dpp v9, v9, v9 quad_perm:[1,0,3,2] row_mask:0xf bank_mask:0xf
    s_nop 0
    v_add_f32_dpp v8, v8, v8 quad_perm:[2,3,0,1] row_mask:0xf bank_mask:0xf
    v_add_f32_dpp v9, v9, v9 quad_perm:[2,3,0,1] row_mask:0xf bank_mask:0xf
    s_nop 0
    v_add_f32_dpp v8, v8, v8 row_half_mirror row_mask:0xf bank_mask:0xf
    v_add_f32_dpp v9, v9, v9 row_half_mirror row_mask:0xf bank_mask:0xf
    v_cvt_pk_bf16_f32 v10, v8, v9
    v_lshlrev_b32 v8, 16, v10
    v_and_b32 v9, 0xffff0000, v10
    v_mul_f32 v8, 0x3d93cd3a, v8
    v_mul_f32 v9, 0x3d93cd3a, v9
    v_cvt_pk_bf16_f32 v10, v8, v9
    v_lshlrev_b32 v50, 16, v10
    v_and_b32 v51, 0xffff0000, v10
    v_max3_f32 v7, v7, v50, v51
    s_add_u32 m0, s85, 2048
    s_add_u32 s100, s90, 102400
    buffer_load_dwordx4 v2, s[36:39], s100 offen  lds
    s_add_u32 m0, s85, 6144
    s_add_u32 s100, s90, 102528
    buffer_load_dwordx4 v2, s[36:39], s100 offen  lds
    s_waitcnt vmcnt(9)
    s_add_u32 s3, s80, 273408
    buffer_load_dwordx4 v[148:151], v1, s[28:31], s3 offen offset:0 nt
    buffer_load_dwordx4 v[152:155], v1, s[28:31], s3 offen offset:128 nt
    buffer_load_dwordx4 v[156:159], v1, s[28:31], s3 offen offset:256 nt
    s_barrier
    s_add_u32 m0, s85, 3072
    s_add_u32 s100, s90, 112640
    buffer_load_dwordx4 v2, s[36:39], s100 offen  lds
    s_waitcnt vmcnt(7)
    s_add_u32 s3, s80, 279552
    buffer_load_dwordx4 v[160:163], v1, s[28:31], s3 offen offset:0 nt
    buffer_load_dwordx4 v[164:167], v1, s[28:31], s3 offen offset:128 nt
    buffer_load_dwordx4 v[168:171], v1, s[28:31], s3 offen offset:256 nt
    s_barrier
    v_add_u32 v19, 1, v19
    buffer_store_dword v19, v18, s[48:51], s20 offen
    s_add_u32 s24, s0, 5
    v_subrev_u32 v6, s24, v6
    v_cmp_gt_u32 s[68:69], 64, v6
    s_xor_b32 s24, s21, 25
    s_bitcmp1_b32 s68, s24
    s_cbranch_scc1 L_nh4_0
    s_xor_b32 s24, s25, 241
    s_mul_i32 s24, s24, 393216
    s_add_u32 s24, s24, 279552
    buffer_load_dword a240, v16, s[28:31], s24 offen nt
    buffer_load_dword a240, v16, s[28:31], s24 offen
    s_branch L_nh4
L_nh4_0:
    s_xor_b32 s24, s21, 14
    s_bitcmp1_b32 s68, s24
    s_cbranch_scc1 L_nh4_1
    s_xor_b32 s24, s25, 848
    s_mul_i32 s24, s24, 393216
    s_add_u32 s24, s24, 285696
    buffer_load_dword a240, v16, s[28:31], s24 offen nt
    buffer_load_dword a240, v16, s[28:31], s24 offen
    s_branch L_nh4
L_nh4_1:
    s_xor_b32 s24, s21, 19
    s_bitcmp1_b32 s68, s24
    s_cbranch_scc1 L_nh4
    s_xor_b32 s24, s25, 417
    s_mul_i32 s24, s24, 393216
    s_add_u32 s24, s24, 291840
    buffer_load_dword a240, v16, s[28:31], s24 offen nt
    buffer_load_dword a240, v16, s[28:31], s24 offen
L_nh4:
    buffer_load_dword v14, v15, s[48:51], s23 offen sc1
    v_mov_b32 v8, 0
    v_mov_b32 v9, 0
    v_dot2c_f32_bf16 v8, v112, v20
    v_dot2c_f32_bf16 v9, v124, v20
    v_dot2c_f32_bf16 v8, v113, v21
    v_dot2c_f32_bf16 v9, v125, v21
    v_dot2c_f32_bf16 v8, v114, v22
    v_dot2c_f32_bf16 v9, v126, v22
    v_dot2c_f32_bf16 v8, v115, v23
    v_dot2c_f32_bf16 v9, v127, v23
    v_dot2c_f32_bf16 v8, v116, v24
    v_dot2c_f32_bf16 v9, v128, v24
    v_dot2c_f32_bf16 v8, v117, v25
    v_dot2c_f32_bf16 v9, v129, v25
    v_dot2c_f32_bf16 v8, v118, v26
    v_dot2c_f32_bf16 v9, v130, v26
    v_dot2c_f32_bf16 v8, v119, v27
    v_dot2c_f32_bf16 v9, v131, v27
    v_dot2c_f32_bf16 v8, v120, v28
    v_dot2c_f32_bf16 v9, v132, v28
    v_dot2c_f32_bf16 v8, v121, v29
    v_dot2c_f32_bf16 v9, v133, v29
    v_dot2c_f32_bf16 v8, v122, v30
    v_dot2c_f32_bf16 v9, v134, v30
    v_dot2c_f32_bf16 v8, v123, v31
    v_dot2c_f32_bf16 v9, v135, v31
    s_nop 1
    v_add_f32_dpp v8, v8, v8 quad_perm:[1,0,3,2] row_mask:0xf bank_mask:0xf
    v_add_f32_dpp v9, v9, v9 quad_perm:[1,0,3,2] row_mask:0xf bank_mask:0xf
    s_nop 0
    v_add_f32_dpp v8, v8, v8 quad_perm:[2,3,0,1] row_mask:0xf bank_mask:0xf
    v_add_f32_dpp v9, v9, v9 quad_perm:[2,3,0,1] row_mask:0xf bank_mask:0xf
    s_nop 0
    v_add_f32_dpp v8, v8, v8 row_half_mirror row_mask:0xf bank_mask:0xf
    v_add_f32_dpp v9, v9, v9 row_half_mirror row_mask:0xf bank_mask:0xf
    v_cvt_pk_bf16_f32 v10, v8, v9
    v_lshlrev_b32 v8, 16, v10
    v_and_b32 v9, 0xffff0000, v10
    v_mul_f32 v8, 0x3d93cd3a, v8
    v_mul_f32 v9, 0x3d93cd3a, v9
    v_cvt_pk_bf16_f32 v10, v8, v9
    v_lshlrev_b32 v52, 16, v10
    v_and_b32 v53, 0xffff0000, v10
    v_max3_f32 v7, v7, v52, v53
    s_add_u32 m0, s85, 7168
    s_add_u32 s100, s90, 112768
    buffer_load_dwordx4 v2, s[36:39], s100 offen  lds
    s_waitcnt vmcnt(8)
    s_add_u32 s3, s80, 285696
    buffer_load_dwordx4 v[172:175], v1, s[28:31], s3 offen offset:0 nt
    buffer_load_dwordx4 v[176:179], v1, s[28:31], s3 offen offset:128 nt
    buffer_load_dwordx4 v[180:183], v1, s[28:31], s3 offen offset:256 nt
    s_barrier
    s_add_u32 m0, s85, 9216
    s_add_u32 s100, s91, 92160
    buffer_load_dwordx4 v2, s[36:39], s100 offen  lds
    s_waitcnt vmcnt(8)
    s_add_u32 s3, s80, 291840
    buffer_load_dwordx4 v[184:187], v1, s[28:31], s3 offen offset:0 nt
    buffer_load_dwordx4 v[188:191], v1, s[28:31], s3 offen offset:128 nt
    buffer_load_dwordx4 v[192:195], v1, s[28:31], s3 offen offset:256 nt
    s_barrier
    v_mov_b32 v8, 0
    v_mov_b32 v9, 0
    v_dot2c_f32_bf16 v8, v136, v20
    v_dot2c_f32_bf16 v9, v148, v20
    v_dot2c_f32_bf16 v8, v137, v21
    v_dot2c_f32_bf16 v9, v149, v21
    v_dot2c_f32_bf16 v8, v138, v22
    v_dot2c_f32_bf16 v9, v150, v22
    v_dot2c_f32_bf16 v8, v139, v23
    v_dot2c_f32_bf16 v9, v151, v23
    v_dot2c_f32_bf16 v8, v140, v24
    v_dot2c_f32_bf16 v9, v152, v24
    v_dot2c_f32_bf16 v8, v141, v25
    v_dot2c_f32_bf16 v9, v153, v25
    v_dot2c_f32_bf16 v8, v142, v26
    v_dot2c_f32_bf16 v9, v154, v26
    v_dot2c_f32_bf16 v8, v143, v27
    v_dot2c_f32_bf16 v9, v155, v27
    v_dot2c_f32_bf16 v8, v144, v28
    v_dot2c_f32_bf16 v9, v156, v28
    v_dot2c_f32_bf16 v8, v145, v29
    v_dot2c_f32_bf16 v9, v157, v29
    v_dot2c_f32_bf16 v8, v146, v30
    v_dot2c_f32_bf16 v9, v158, v30
    v_dot2c_f32_bf16 v8, v147, v31
    v_dot2c_f32_bf16 v9, v159, v31
    s_nop 1
    v_add_f32_dpp v8, v8, v8 quad_perm:[1,0,3,2] row_mask:0xf bank_mask:0xf
    v_add_f32_dpp v9, v9, v9 quad_perm:[1,0,3,2] row_mask:0xf bank_mask:0xf
    s_nop 0
    v_add_f32_dpp v8, v8, v8 quad_perm:[2,3,0,1] row_mask:0xf bank_mask:0xf
    v_add_f32_dpp v9, v9, v9 quad_perm:[2,3,0,1] row_mask:0xf bank_mask:0xf
    s_nop 0
    v_add_f32_dpp v8, v8, v8 row_half_mirror row_mask:0xf bank_mask:0xf
    v_add_f32_dpp v9, v9, v9 row_half_mirror row_mask:0xf bank_mask:0xf
    v_cvt_pk_bf16_f32 v10, v8, v9
    v_lshlrev_b32 v8, 16, v10
    v_and_b32 v9, 0xffff0000, v10
    v_mul_f32 v8, 0x3d93cd3a, v8
    v_mul_f32 v9, 0x3d93cd3a, v9
    v_cvt_pk_bf16_f32 v10, v8, v9
    v_lshlrev_b32 v54, 16, v10
    v_and_b32 v55, 0xffff0000, v10
    v_max3_f32 v7, v7, v54, v55
    s_add_u32 m0, s85, 10240
    s_add_u32 s100, s90, 122880
    buffer_load_dwordx4 v2, s[36:39], s100 offen  lds
    s_waitcnt vmcnt(6)
    s_add_u32 s3, s80, 297984
    buffer_load_dwordx4 v[196:199], v1, s[28:31], s3 offen offset:0 nt
    buffer_load_dwordx4 v[200:203], v1, s[28:31], s3 offen offset:128 nt
    buffer_load_dwordx4 v[204:207], v1, s[28:31], s3 offen offset:256 nt
    s_barrier
    v_add_u32 v19, 1, v19
    buffer_store_dword v19, v18, s[48:51], s20 offen
    s_add_u32 s24, s0, 6
    v_subrev_u32 v14, s24, v14
    v_cmp_gt_u32 s[68:69], 64, v14
    s_xor_b32 s24, s21, 6
    s_bitcmp1_b32 s68, s24
    s_cbranch_scc1 L_nh5_0
    s_xor_b32 s24, s25, 768
    s_mul_i32 s24, s24, 393216
    s_add_u32 s24, s24, 297984
    buffer_load_dword a240, v16, s[28:31], s24 offen nt
    buffer_load_dword a240, v16, s[28:31], s24 offen
    s_branch L_nh5
L_nh5_0:
    s_xor_b32 s24, s21, 27
    s_bitcmp1_b32 s68, s24
    s_cbranch_scc1 L_nh5_1
    s_xor_b32 s24, s25, 497
    s_mul_i32 s24, s24, 393216
    s_add_u32 s24, s24, 304128
    buffer_load_dword a240, v16, s[28:31], s24 offen nt
    buffer_load_dword a240, v16, s[28:31], s24 offen
    s_branch L_nh5
L_nh5_1:
    s_xor_b32 s24, s21, 12
    s_bitcmp1_b32 s68, s24
    s_cbranch_scc1 L_nh5
    s_xor_b32 s24, s25, 592
    s_mul_i32 s24, s24, 393216
    s_add_u32 s24, s24, 310272
    buffer_load_dword a240, v16, s[28:31], s24 offen nt
    buffer_load_dword a240, v16, s[28:31], s24 offen
L_nh5:
    buffer_load_dword v6, v15, s[48:51], s23 offen sc1
    s_add_u32 m0, s85, 14336
    s_add_u32 s100, s90, 123008
    buffer_load_dwordx4 v2, s[36:39], s100 offen  lds
    s_add_u32 m0, s85, 11264
    s_add_u32 s100, s90, 133120
    buffer_load_dwordx4 v2, s[36:39], s100 offen  lds
    s_waitcnt vmcnt(9)
    s_add_u32 s3, s80, 304128
    buffer_load_dwordx4 v[208:211], v1, s[28:31], s3 offen offset:0 nt
    buffer_load_dwordx4 v[212:215], v1, s[28:31], s3 offen offset:128 nt
    buffer_load_dwordx4 v[216:219], v1, s[28:31], s3 offen offset:256 nt
    s_barrier
    v_mov_b32 v8, 0
    v_mov_b32 v9, 0
    v_dot2c_f32_bf16 v8, v160, v20
    v_dot2c_f32_bf16 v9, v172, v20
    v_dot2c_f32_bf16 v8, v161, v21
    v_dot2c_f32_bf16 v9, v173, v21
    v_dot2c_f32_bf16 v8, v162, v22
    v_dot2c_f32_bf16 v9, v174, v22
    v_dot2c_f32_bf16 v8, v163, v23
    v_dot2c_f32_bf16 v9, v175, v23
    v_dot2c_f32_bf16 v8, v164, v24
    v_dot2c_f32_bf16 v9, v176, v24
    v_dot2c_f32_bf16 v8, v165, v25
    v_dot2c_f32_bf16 v9, v177, v25
    v_dot2c_f32_bf16 v8, v166, v26
    v_dot2c_f32_bf16 v9, v178, v26
    v_dot2c_f32_bf16 v8, v167, v27
    v_dot2c_f32_bf16 v9, v179, v27
    v_dot2c_f32_bf16 v8, v168, v28
    v_dot2c_f32_bf16 v9, v180, v28
    v_dot2c_f32_bf16 v8, v169, v29
    v_dot2c_f32_bf16 v9, v181, v29
    v_dot2c_f32_bf16 v8, v170, v30
    v_dot2c_f32_bf16 v9, v182, v30
    v_dot2c_f32_bf16 v8, v171, v31
    v_dot2c_f32_bf16 v9, v183, v31
    s_nop 1
    v_add_f32_dpp v8, v8, v8 quad_perm:[1,0,3,2] row_mask:0xf bank_mask:0xf
    v_add_f32_dpp v9, v9, v9 quad_perm:[1,0,3,2] row_mask:0xf bank_mask:0xf
    s_nop 0
    v_add_f32_dpp v8, v8, v8 quad_perm:[2,3,0,1] row_mask:0xf bank_mask:0xf
    v_add_f32_dpp v9, v9, v9 quad_perm:[2,3,0,1] row_mask:0xf bank_mask:0xf
    s_nop 0
    v_add_f32_dpp v8, v8, v8 row_half_mirror row_mask:0xf bank_mask:0xf
    v_add_f32_dpp v9, v9, v9 row_half_mirror row_mask:0xf bank_mask:0xf
    v_cvt_pk_bf16_f32 v10, v8, v9
    v_lshlrev_b32 v8, 16, v10
    v_and_b32 v9, 0xffff0000, v10
    v_mul_f32 v8, 0x3d93cd3a, v8
    v_mul_f32 v9, 0x3d93cd3a, v9
    v_cvt_pk_bf16_f32 v10, v8, v9
    v_lshlrev_b32 v56, 16, v10
    v_and_b32 v57, 0xffff0000, v10
    v_max3_f32 v7, v7, v56, v57
    s_add_u32 m0, s85, 15360
    s_add_u32 s100, s90, 133248
    buffer_load_dwordx4 v2, s[36:39], s100 offen  lds
    s_waitcnt lgkmcnt(0)
    v_xor_b32 v8, 4, v3
    v_mov_b32 v9, 3
    ds_write_b32 v8, v9
    ds_read_b64_tr_b16 a[80:81], v4 offset:0
    ds_read_b64_tr_b16 a[82:83], v4 offset:512
    ds_read_b64_tr_b16 a[84:85], v4 offset:32
    ds_read_b64_tr_b16 a[86:87], v4 offset:544
    ds_read_b64_tr_b16 a[88:89], v4 offset:64
    ds_read_b64_tr_b16 a[90:91], v4 offset:576
    s_waitcnt vmcnt(9)
    s_add_u32 s3, s80, 310272
    buffer_load_dwordx4 v[220:223], v1, s[28:31], s3 offen offset:0 nt
    buffer_load_dwordx4 v[224:227], v1, s[28:31], s3 offen offset:128 nt
    buffer_load_dwordx4 v[228:231], v1, s[28:31], s3 offen offset:256 nt
    s_barrier
    ds_read_b64_tr_b16 a[92:93], v4 offset:96
    ds_read_b64_tr_b16 a[94:95], v4 offset:608
    ds_read_b64_tr_b16 a[96:97], v4 offset:4096
    ds_read_b64_tr_b16 a[98:99], v4 offset:4608
    ds_read_b64_tr_b16 a[100:101], v4 offset:4128
    ds_read_b64_tr_b16 a[102:103], v4 offset:4640
    s_add_u32 m0, s85, 18432
    s_add_u32 s100, s91, 122880
    buffer_load_dwordx4 v2, s[36:39], s100 offen  lds
    ds_read_b64_tr_b16 a[104:105], v4 offset:4160
    ds_read_b64_tr_b16 a[106:107], v4 offset:4672
    ds_read_b64_tr_b16 a[108:109], v4 offset:4192
    ds_read_b64_tr_b16 a[110:111], v4 offset:4704
    s_waitcnt vmcnt(6)
    s_add_u32 s3, s80, 316416
    buffer_load_dwordx4 v[232:235], v1, s[28:31], s3 offen offset:0 nt
    buffer_load_dwordx4 v[236:239], v1, s[28:31], s3 offen offset:128 nt
    buffer_load_dwordx4 v[240:243], v1, s[28:31], s3 offen offset:256 nt
    s_barrier
    v_add_u32 v19, 1, v19
    buffer_store_dword v19, v18, s[48:51], s20 offen
    s_add_u32 s24, s0, 7
    v_subrev_u32 v6, s24, v6
    v_cmp_gt_u32 s[68:69], 64, v6
    s_xor_b32 s24, s21, 30
    s_bitcmp1_b32 s68, s24
    s_cbranch_scc1 L_nh6_0
    s_xor_b32 s24, s25, 1008
    s_mul_i32 s24, s24, 393216
    s_add_u32 s24, s24, 316416
    buffer_load_dword a240, v16, s[28:31], s24 offen nt
    buffer_load_dword a240, v16, s[28:31], s24 offen
    s_branch L_nh6
L_nh6_0:
    s_xor_b32 s24, s21, 11
    s_bitcmp1_b32 s68, s24
    s_cbranch_scc1 L_nh6_1
    s_xor_b32 s24, s25, 337
    s_mul_i32 s24, s24, 393216
    s_add_u32 s24, s24, 322560
    buffer_load_dword a240, v16, s[28:31], s24 offen nt
    buffer_load_dword a240, v16, s[28:31], s24 offen
    s_branch L_nh6
L_nh6_1:
    s_xor_b32 s24, s21, 22
    s_bitcmp1_b32 s68, s24
    s_cbranch_scc1 L_nh6
    s_xor_b32 s24, s25, 928
    s_mul_i32 s24, s24, 393216
    s_add_u32 s24, s24, 0
    buffer_load_dword a240, v16, s[32:35], s24 offen nt
    buffer_load_dword a240, v16, s[32:35], s24 offen
L_nh6:
    buffer_load_dword v14, v15, s[48:51], s23 offen sc1
    ds_read_b32 v8, v3
    s_add_u32 m0, s85, 12288
    s_add_u32 s100, s90, 143360
    buffer_load_dwordx4 v2, s[36:39], s100 offen  lds
    s_waitcnt lgkmcnt(0)
    v_cmp_gt_u32 vcc, 3, v8
    s_nop 1
    s_cbranch_vccnz L_fb_h2
L_fb_h2_ret:
    ds_read_b64_tr_b16 a[112:113], v5 offset:8192
    ds_read_b64_tr_b16 a[114:115], v5 offset:8704
    s_waitcnt vmcnt(8)
    s_add_u32 s3, s80, 322560
    buffer_load_dwordx4 v[244:247], v17, s[28:31], s3 offen offset:0 nt
    buffer_load_dwordx4 v[248:251], v17, s[28:31], s3 offen offset:128 nt
    buffer_load_dwordx4 v[252:255], v17, s[28:31], s3 offen offset:256 nt
    s_barrier
    ds_read_b64_tr_b16 a[116:117], v5 offset:8224
    ds_read_b64_tr_b16 a[118:119], v5 offset:8736
    v_mov_b32 v8, 0
    v_mov_b32 v9, 0
    v_dot2c_f32_bf16 v8, v184, v20
    v_dot2c_f32_bf16 v9, v196, v20
    v_dot2c_f32_bf16 v8, v185, v21
    v_dot2c_f32_bf16 v9, v197, v21
    v_dot2c_f32_bf16 v8, v186, v22
    v_dot2c_f32_bf16 v9, v198, v22
    v_dot2c_f32_bf16 v8, v187, v23
    v_dot2c_f32_bf16 v9, v199, v23
    v_dot2c_f32_bf16 v8, v188, v24
    v_dot2c_f32_bf16 v9, v200, v24
    v_dot2c_f32_bf16 v8, v189, v25
    v_dot2c_f32_bf16 v9, v201, v25
    v_dot2c_f32_bf16 v8, v190, v26
    v_dot2c_f32_bf16 v9, v202, v26
    v_dot2c_f32_bf16 v8, v191, v27
    v_dot2c_f32_bf16 v9, v203, v27
    v_dot2c_f32_bf16 v8, v192, v28
    v_dot2c_f32_bf16 v9, v204, v28
    v_dot2c_f32_bf16 v8, v193, v29
    v_dot2c_f32_bf16 v9, v205, v29
    v_dot2c_f32_bf16 v8, v194, v30
    v_dot2c_f32_bf16 v9, v206, v30
    v_dot2c_f32_bf16 v8, v195, v31
    v_dot2c_f32_bf16 v9, v207, v31
    s_nop 1
    v_add_f32_dpp v8, v8, v8 quad_perm:[1,0,3,2] row_mask:0xf bank_mask:0xf
    v_add_f32_dpp v9, v9, v9 quad_perm:[1,0,3,2] row_mask:0xf bank_mask:0xf
    s_nop 0
    v_add_f32_dpp v8, v8, v8 quad_perm:[2,3,0,1] row_mask:0xf bank_mask:0xf
    v_add_f32_dpp v9, v9, v9 quad_perm:[2,3,0,1] row_mask:0xf bank_mask:0xf
    s_nop 0
    v_add_f32_dpp v8, v8, v8 row_half_mirror row_mask:0xf bank_mask:0xf
    v_add_f32_dpp v9, v9, v9 row_half_mirror row_mask:0xf bank_mask:0xf
    v_cvt_pk_bf16_f32 v10, v8, v9
    v_lshlrev_b32 v8, 16, v10
    v_and_b32 v9, 0xffff0000, v10
    v_mul_f32 v8, 0x3d93cd3a, v8
    v_mul_f32 v9, 0x3d93cd3a, v9
    v_cvt_pk_bf16_f32 v10, v8, v9
    v_lshlrev_b32 v58, 16, v10
    v_and_b32 v59, 0xffff0000, v10
    v_max3_f32 v7, v7, v58, v59
    s_add_u32 m0, s85, 16384
    s_add_u32 s100, s90, 143488
    buffer_load_dwordx4 v2, s[36:39], s100 offen  lds
    s_waitcnt vmcnt(8)
    buffer_load_dwordx4 v[64:67], v1, s[32:35], s80 offen offset:0 nt
    buffer_load_dwordx4 v[68:71], v1, s[32:35], s80 offen offset:128 nt
    buffer_load_dwordx4 v[72:75], v1, s[32:35], s80 offen offset:256 nt
    s_barrier
    v_mov_b32 v8, 0
    v_mov_b32 v9, 0
    v_dot2c_f32_bf16 v8, v208, v20
    v_dot2c_f32_bf16 v9, v220, v20
    v_dot2c_f32_bf16 v8, v209, v21
    v_dot2c_f32_bf16 v9, v221, v21
    v_dot2c_f32_bf16 v8, v210, v22
    v_dot2c_f32_bf16 v9, v222, v22
    v_dot2c_f32_bf16 v8, v211, v23
    v_dot2c_f32_bf16 v9, v223, v23
    v_dot2c_f32_bf16 v8, v212, v24
    v_dot2c_f32_bf16 v9, v224, v24
    v_dot2c_f32_bf16 v8, v213, v25
    v_dot2c_f32_bf16 v9, v225, v25
    v_dot2c_f32_bf16 v8, v214, v26
    v_dot2c_f32_bf16 v9, v226, v26
    v_dot2c_f32_bf16 v8, v215, v27
    v_dot2c_f32_bf16 v9, v227, v27
    v_dot2c_f32_bf16 v8, v216, v28
    v_dot2c_f32_bf16 v9, v228, v28
    v_dot2c_f32_bf16 v8, v217, v29
    v_dot2c_f32_bf16 v9, v229, v29
    v_dot2c_f32_bf16 v8, v218, v30
    v_dot2c_f32_bf16 v9, v230, v30
    v_dot2c_f32_bf16 v8, v219, v31
    v_dot2c_f32_bf16 v9, v231, v31
    s_nop 1
    v_add_f32_dpp v8, v8, v8 quad_perm:[1,0,3,2] row_mask:0xf bank_mask:0xf
    v_add_f32_dpp v9, v9, v9 quad_perm:[1,0,3,2] row_mask:0xf bank_mask:0xf
    s_nop 0
    v_add_f32_dpp v8, v8, v8 quad_perm:[2,3,0,1] row_mask:0xf bank_mask:0xf
    v_add_f32_dpp v9, v9, v9 quad_perm:[2,3,0,1] row_mask:0xf bank_mask:0xf
    s_nop 0
    v_add_f32_dpp v8, v8, v8 row_half_mirror row_mask:0xf bank_mask:0xf
    v_add_f32_dpp v9, v9, v9 row_half_mirror row_mask:0xf bank_mask:0xf
    v_cvt_pk_bf16_f32 v10, v8, v9
    v_lshlrev_b32 v8, 16, v10
    v_and_b32 v9, 0xffff0000, v10
    v_mul_f32 v8, 0x3d93cd3a, v8
    v_mul_f32 v9, 0x3d93cd3a, v9
    v_cvt_pk_bf16_f32 v10, v8, v9
    v_lshlrev_b32 v60, 16, v10
    v_and_b32 v61, 0xffff0000, v10
    v_max3_f32 v7, v7, v60, v61
    s_add_u32 m0, s85, 13312
    s_add_u32 s100, s90, 153600
    buffer_load_dwordx4 v2, s[36:39], s100 offen  lds
    s_waitcnt vmcnt(6)
    s_add_u32 s3, s80, 6144
    buffer_load_dwordx4 v[76:79], v1, s[32:35], s3 offen offset:0 nt
    buffer_load_dwordx4 v[80:83], v1, s[32:35], s3 offen offset:128 nt
    buffer_load_dwordx4 v[84:87], v1, s[32:35], s3 offen offset:256 nt
    s_barrier
    v_add_u32 v19, 1, v19
    buffer_store_dword v19, v18, s[48:51], s20 offen
    s_add_u32 s24, s0, 8
    v_subrev_u32 v14, s24, v14
    v_cmp_gt_u32 s[68:69], 64, v14
    s_xor_b32 s24, s21, 13
    s_bitcmp1_b32 s68, s24
    s_cbranch_scc1 L_nh7_0
    s_xor_b32 s24, s25, 593
    s_mul_i32 s24, s24, 393216
    s_add_u32 s24, s24, 6144
    buffer_load_dword a240, v16, s[32:35], s24 offen nt
    buffer_load_dword a240, v16, s[32:35], s24 offen
    s_branch L_nh7
L_nh7_0:
    s_xor_b32 s24, s21, 17
    s_bitcmp1_b32 s68, s24
    s_cbranch_scc1 L_nh7_1
    s_xor_b32 s24, s25, 161
    s_mul_i32 s24, s24, 393216
    s_add_u32 s24, s24, 12288
    buffer_load_dword a240, v16, s[32:35], s24 offen nt
    buffer_load_dword a240, v16, s[32:35], s24 offen
    s_branch L_nh7
L_nh7_1:
    s_xor_b32 s24, s21, 20
    s_bitcmp1_b32 s68, s24
    s_cbranch_scc1 L_nh7
    s_xor_b32 s24, s25, 672
    s_mul_i32 s24, s24, 393216
    s_add_u32 s24, s24, 18432
    buffer_load_dword a240, v16, s[32:35], s24 offen nt
    buffer_load_dword a240, v16, s[32:35], s24 offen
L_nh7:
    buffer_load_dword v6, v15, s[48:51], s23 offen sc1
    s_add_u32 m0, s85, 17408
    s_add_u32 s100, s90, 153728
    buffer_load_dwordx4 v2, s[36:39], s100 offen  lds
    s_add_u32 m0, s85, 19456
    s_add_u32 s100, s91, 133120
    buffer_load_dwordx4 v2, s[36:39], s100 offen  lds
    s_waitcnt vmcnt(9)
    s_add_u32 s3, s80, 12288
    buffer_load_dwordx4 v[88:91], v1, s[32:35], s3 offen offset:0 nt
    buffer_load_dwordx4 v[92:95], v1, s[32:35], s3 offen offset:128 nt
    buffer_load_dwordx4 v[96:99], v1, s[32:35], s3 offen offset:256 nt
    s_barrier
    v_mov_b32 v8, 0
    v_mov_b32 v9, 0
    v_dot2c_f32_bf16 v8, v232, v20
    v_dot2c_f32_bf16 v9, v244, v20
    v_dot2c_f32_bf16 v8, v233, v21
    v_dot2c_f32_bf16 v9, v245, v21
    v_dot2c_f32_bf16 v8, v234, v22
    v_dot2c_f32_bf16 v9, v246, v22
    v_dot2c_f32_bf16 v8, v235, v23
    v_dot2c_f32_bf16 v9, v247, v23
    v_dot2c_f32_bf16 v8, v236, v24
    v_dot2c_f32_bf16 v9, v248, v24
    v_dot2c_f32_bf16 v8, v237, v25
    v_dot2c_f32_bf16 v9, v249, v25
    v_dot2c_f32_bf16 v8, v238, v26
    v_dot2c_f32_bf16 v9, v250, v26
    v_dot2c_f32_bf16 v8, v239, v27
    v_dot2c_f32_bf16 v9, v251, v27
    v_dot2c_f32_bf16 v8, v240, v28
    v_dot2c_f32_bf16 v9, v252, v28
    v_dot2c_f32_bf16 v8, v241, v29
    v_dot2c_f32_bf16 v9, v253, v29
    v_dot2c_f32_bf16 v8, v242, v30
    v_dot2c_f32_bf16 v9, v254, v30
    v_dot2c_f32_bf16 v8, v243, v31
    v_dot2c_f32_bf16 v9, v255, v31
    s_nop 1
    v_add_f32_dpp v8, v8, v8 quad_perm:[1,0,3,2] row_mask:0xf bank_mask:0xf
    v_add_f32_dpp v9, v9, v9 quad_perm:[1,0,3,2] row_mask:0xf bank_mask:0xf
    s_nop 0
    v_add_f32_dpp v8, v8, v8 quad_perm:[2,3,0,1] row_mask:0xf bank_mask:0xf
    v_add_f32_dpp v9, v9, v9 quad_perm:[2,3,0,1] row_mask:0xf bank_mask:0xf
    s_nop 0
    v_add_f32_dpp v8, v8, v8 row_half_mirror row_mask:0xf bank_mask:0xf
    v_add_f32_dpp v9, v9, v9 row_half_mirror row_mask:0xf bank_mask:0xf
    v_cvt_pk_bf16_f32 v10, v8, v9
    v_lshlrev_b32 v8, 16, v10
    v_and_b32 v9, 0xffff0000, v10
    v_mul_f32 v8, 0x3d93cd3a, v8
    v_mul_f32 v9, 0x3d93cd3a, v9
    v_cvt_pk_bf16_f32 v10, v8, v9
    v_lshlrev_b32 v62, 16, v10
    v_and_b32 v63, 0xffff0000, v10
    v_max3_f32 v7, v7, v62, v63
    s_add_u32 m0, s85, 20480
    s_add_u32 s100, s90, 0
    s_add_u32 s100, s100, s101
    buffer_load_dwordx4 v2, s[40:43], s100 offen  lds
    v_max_f32_dpp v7, v7, v7 row_ror:8 row_mask:0xf bank_mask:0xf
    v_mov_b32 v8, v7
    s_nop 1
    v_permlane16_swap_b32 v7, v8
    v_max_f32 v7, v7, v8
    v_mov_b32 v8, v7
    s_nop 1
    v_permlane32_swap_b32 v7, v8
    v_max_f32 v7, v7, v8
    s_mov_b32 s81, 0x3fb8aa3b
    v_mul_f32 v8, s81, v7
    v_mov_b32 v9, 0
    v_mov_b32 v10, 0
    v_fma_f32 v32, v32, s81, -v8
    v_fma_f32 v33, v33, s81, -v8
    v_fma_f32 v34, v34, s81, -v8
    v_fma_f32 v35, v35, s81, -v8
    v_exp_f32 v32, v32
    v_exp_f32 v33, v33
    v_exp_f32 v34, v34
    v_exp_f32 v35, v35
    v_add_f32 v9, v9, v32
    v_add_f32 v10, v10, v33
    v_add_f32 v9, v9, v34
    v_add_f32 v10, v10, v35
    v_cvt_pk_bf16_f32 v32, v32, v32
    v_cvt_pk_bf16_f32 v33, v33, v33
    v_cvt_pk_bf16_f32 v34, v34, v34
    v_cvt_pk_bf16_f32 v35, v35, v35
    v_fma_f32 v36, v36, s81, -v8
    v_fma_f32 v37, v37, s81, -v8
    v_fma_f32 v38, v38, s81, -v8
    v_fma_f32 v39, v39, s81, -v8
    v_exp_f32 v36, v36
    v_exp_f32 v37, v37
    v_exp_f32 v38, v38
    v_exp_f32 v39, v39
    v_add_f32 v9, v9, v36
    v_add_f32 v10, v10, v37
    v_add_f32 v9, v9, v38
    v_add_f32 v10, v10, v39
    v_cvt_pk_bf16_f32 v36, v36, v36
    v_cvt_pk_bf16_f32 v37, v37, v37
    v_cvt_pk_bf16_f32 v38, v38, v38
    v_cvt_pk_bf16_f32 v39, v39, v39
    v_fma_f32 v40, v40, s81, -v8
    v_fma_f32 v41, v41, s81, -v8
    v_fma_f32 v42, v42, s81, -v8
    v_fma_f32 v43, v43, s81, -v8
    v_exp_f32 v40, v40
    v_exp_f32 v41, v41
    v_exp_f32 v42, v42
    v_exp_f32 v43, v43
    v_add_f32 v9, v9, v40
    v_add_f32 v10, v10, v41
    v_add_f32 v9, v9, v42
    v_add_f32 v10, v10, v43
    v_cvt_pk_bf16_f32 v40, v40, v40
    v_cvt_pk_bf16_f32 v41, v41, v41
    v_cvt_pk_bf16_f32 v42, v42, v42
    v_cvt_pk_bf16_f32 v43, v43, v43
    s_waitcnt vmcnt(9)
    s_add_u32 s3, s80, 18432
    buffer_load_dwordx4 v[100:103], v1, s[32:35], s3 offen offset:0 nt
    buffer_load_dwordx4 v[104:107], v1, s[32:35], s3 offen offset:128 nt
    buffer_load_dwordx4 v[108:111], v1, s[32:35], s3 offen offset:256 nt
    s_barrier
    v_fma_f32 v44, v44, s81, -v8
    v_fma_f32 v45, v45, s81, -v8
    v_fma_f32 v46, v46, s81, -v8
    v_fma_f32 v47, v47, s81, -v8
    v_exp_f32 v44, v44
    v_exp_f32 v45, v45
    v_exp_f32 v46, v46
    v_exp_f32 v47, v47
    v_add_f32 v9, v9, v44
    v_add_f32 v10, v10, v45
    v_add_f32 v9, v9, v46
    v_add_f32 v10, v10, v47
    v_cvt_pk_bf16_f32 v44, v44, v44
    v_cvt_pk_bf16_f32 v45, v45, v45
    v_cvt_pk_bf16_f32 v46, v46, v46
    v_cvt_pk_bf16_f32 v47, v47, v47
    v_fma_f32 v48, v48, s81, -v8
    v_fma_f32 v49, v49, s81, -v8
    v_fma_f32 v50, v50, s81, -v8
    v_fma_f32 v51, v51, s81, -v8
    v_exp_f32 v48, v48
    v_exp_f32 v49, v49
    v_exp_f32 v50, v50
    v_exp_f32 v51, v51
    v_add_f32 v9, v9, v48
    v_add_f32 v10, v10, v49
    v_add_f32 v9, v9, v50
    v_add_f32 v10, v10, v51
    v_cvt_pk_bf16_f32 v48, v48, v48
    v_cvt_pk_bf16_f32 v49, v49, v49
    v_cvt_pk_bf16_f32 v50, v50, v50
    v_cvt_pk_bf16_f32 v51, v51, v51
    v_fma_f32 v52, v52, s81, -v8
    v_fma_f32 v53, v53, s81, -v8
    v_fma_f32 v54, v54, s81, -v8
    v_fma_f32 v55, v55, s81, -v8
    v_exp_f32 v52, v52
    v_exp_f32 v53, v53
    v_exp_f32 v54, v54
    v_exp_f32 v55, v55
    v_add_f32 v9, v9, v52
    v_add_f32 v10, v10, v53
    v_add_f32 v9, v9, v54
    v_add_f32 v10, v10, v55
    v_cvt_pk_bf16_f32 v52, v52, v52
    v_cvt_pk_bf16_f32 v53, v53, v53
    v_cvt_pk_bf16_f32 v54, v54, v54
    v_fma_f32 v56, v56, s81, -v8
    v_fma_f32 v57, v57, s81, -v8
    v_fma_f32 v58, v58, s81, -v8
    v_fma_f32 v59, v59, s81, -v8
    v_exp_f32 v56, v56
    v_exp_f32 v57, v57
    v_exp_f32 v58, v58
    v_exp_f32 v59, v59
    v_add_f32 v9, v9, v56
    v_add_f32 v10, v10, v57
    v_add_f32 v9, v9, v58
    v_add_f32 v10, v10, v59
    v_fma_f32 v60, v60, s81, -v8
    v_fma_f32 v61, v61, s81, -v8
    v_fma_f32 v62, v62, s81, -v8
    v_fma_f32 v63, v63, s81, -v8
    v_exp_f32 v60, v60
    v_exp_f32 v61, v61
    v_exp_f32 v62, v62
    v_exp_f32 v63, v63
    v_add_f32 v9, v9, v60
    v_add_f32 v10, v10, v61
    v_add_f32 v9, v9, v62
    v_add_f32 v10, v10, v63
    s_add_u32 m0, s85, 24576
    s_add_u32 s100, s90, 128
    s_add_u32 s100, s100, s101
    buffer_load_dwordx4 v2, s[40:43], s100 offen  lds
    v_add_f32 v9, v9, v10
    s_nop 1
    v_add_f32_dpp v9, v9, v9 row_ror:8 row_mask:0xf bank_mask:0xf
    v_mov_b32 v10, v9
    s_nop 1
    v_permlane16_swap_b32 v9, v10
    v_add_f32 v9, v9, v10
    v_mov_b32 v10, v9
    s_nop 1
    v_permlane32_swap_b32 v9, v10
    v_add_f32 v9, v9, v10
    v_mov_b32 v10, v9
    v_mov_b32 v9, s60
    v_mov_b32 v11, s60
    buffer_store_dwordx4 v[8:11], v18, s[48:51], s88 offen sc1
    v_mov_b32 v7, v8
    s_nop 0
    v_and_b32 v10, 1, v0
    v_mov_b32 v11, 0xffff
    v_lshlrev_b32 v10, 4, v10
    v_lshlrev_b32 v11, v10, v11
    v_bfe_u32 v10, v0, 1, 2
    v_cmp_eq_u32 vcc, 0, v10
    s_nop 1
    v_cndmask_b32 v20, 0, v11, vcc
    v_cmp_eq_u32 vcc, 1, v10
    s_nop 1
    v_cndmask_b32 v21, 0, v11, vcc
    v_cmp_eq_u32 vcc, 2, v10
    s_nop 1
    v_cndmask_b32 v22, 0, v11, vcc
    v_cmp_eq_u32 vcc, 3, v10
    s_nop 1
    v_cndmask_b32 v23, 0, v11, vcc
    v_and_b32 v24, v20, v32
    v_and_b32 v25, v21, v32
    v_and_b32 v26, v22, v32
    v_and_b32 v27, v23, v32
    s_nop 1
    v_mfma_f32_16x16x32_bf16 v[160:163], v[24:27], v[64:67], 0
    v_mfma_f32_16x16x32_bf16 v[164:167], v[24:27], v[68:71], 0
    v_mfma_f32_16x16x32_bf16 v[168:171], v[24:27], v[72:75], 0
    s_waitcnt vmcnt(7)
    s_add_u32 s3, s80, 24576
    buffer_load_dwordx4 v[112:115], v1, s[32:35], s3 offen offset:0 nt
    buffer_load_dwordx4 v[116:119], v1, s[32:35], s3 offen offset:128 nt
    buffer_load_dwordx4 v[120:123], v1, s[32:35], s3 offen offset:256 nt
    s_barrier
    v_add_u32 v19, 1, v19
    buffer_store_dword v19, v18, s[48:51], s20 offen
    s_add_u32 s24, s0, 9
    v_subrev_u32 v6, s24, v6
    v_cmp_gt_u32 s[68:69], 64, v6
    s_xor_b32 s24, s21, 23
    s_bitcmp1_b32 s68, s24
    s_cbranch_scc1 L_nh8_0
    s_xor_b32 s24, s25, 929
    s_mul_i32 s24, s24, 393216
    s_add_u32 s24, s24, 24576
    buffer_load_dword a240, v16, s[32:35], s24 offen nt
    buffer_load_dword a240, v16, s[32:35], s24 offen
    s_branch L_nh8
L_nh8_0:
    s_xor_b32 s24, s21, 24
    s_bitcmp1_b32 s68, s24
    s_cbranch_scc1 L_nh8_1
    s_xor_b32 s24, s25, 240
    s_mul_i32 s24, s24, 393216
    s_add_u32 s24, s24, 30720
    buffer_load_dword a240, v16, s[32:35], s24 offen nt
    buffer_load_dword a240, v16, s[32:35], s24 offen
    s_branch L_nh8
L_nh8_1:
    s_xor_b32 s24, s21, 26
    s_bitcmp1_b32 s68, s24
    s_cbranch_scc1 L_nh8
    s_xor_b32 s24, s25, 496
    s_mul_i32 s24, s24, 393216
    s_add_u32 s24, s24, 36864
    buffer_load_dword a240, v16, s[32:35], s24 offen nt
    buffer_load_dword a240, v16, s[32:35], s24 offen
L_nh8:
    buffer_load_dword v14, v15, s[48:51], s23 offen sc1
    v_and_b32 v28, v20, v33
    v_and_b32 v29, v21, v33
    v_and_b32 v30, v22, v33
    v_and_b32 v31, v23, v33
    s_nop 1
    v_mfma_f32_16x16x32_bf16 v[160:163], v[28:31], v[76:79], v[160:163]
    v_mfma_f32_16x16x32_bf16 v[164:167], v[28:31], v[80:83], v[164:167]
    v_mfma_f32_16x16x32_bf16 v[168:171], v[28:31], v[84:87], v[168:171]
    s_waitcnt lgkmcnt(0)
    v_xor_b32 v8, 4, v3
    v_mov_b32 v9, 4
    ds_write_b32 v8, v9
    ds_read_b64_tr_b16 a[120:121], v4 offset:10240
    ds_read_b64_tr_b16 a[122:123], v4 offset:10752
    ds_read_b64_tr_b16 a[124:125], v4 offset:10272
    ds_read_b64_tr_b16 a[126:127], v4 offset:10784
    ds_read_b64_tr_b16 a[128:129], v4 offset:10304
    ds_read_b64_tr_b16 a[130:131], v4 offset:10816
    s_add_u32 m0, s85, 21504
    s_add_u32 s100, s90, 10240
    s_add_u32 s100, s100, s101
    buffer_load_dwordx4 v2, s[40:43], s100 offen  lds
    ds_read_b64_tr_b16 a[132:133], v4 offset:10336
    ds_read_b64_tr_b16 a[134:135], v4 offset:10848
    ds_read_b64_tr_b16 a[136:137], v4 offset:14336
    ds_read_b64_tr_b16 a[138:139], v4 offset:14848
    ds_read_b64_tr_b16 a[140:141], v4 offset:14368
    ds_read_b64_tr_b16 a[142:143], v4 offset:14880
    s_waitcnt vmcnt(9)
    s_add_u32 s3, s80, 30720
    buffer_load_dwordx4 v[124:127], v1, s[32:35], s3 offen offset:0 nt
    buffer_load_dwordx4 v[128:131], v1, s[32:35], s3 offen offset:128 nt
    buffer_load_dwordx4 v[132:135], v1, s[32:35], s3 offen offset:256 nt
    s_barrier
    ds_read_b64_tr_b16 a[144:145], v4 offset:14400
    ds_read_b64_tr_b16 a[146:147], v4 offset:14912
    ds_read_b64_tr_b16 a[148:149], v4 offset:14432
    ds_read_b64_tr_b16 a[150:151], v4 offset:14944
    s_add_u32 m0, s85, 25600
    s_add_u32 s100, s90, 10368
    s_add_u32 s100, s100, s101
    buffer_load_dwordx4 v2, s[40:43], s100 offen  lds
    ds_read_b32 v8, v3
    s_waitcnt vmcnt(8)
    s_add_u32 s3, s80, 36864
    buffer_load_dwordx4 v[136:139], v1, s[32:35], s3 offen offset:0 nt
    buffer_load_dwordx4 v[140:143], v1, s[32:35], s3 offen offset:128 nt
    buffer_load_dwordx4 v[144:147], v1, s[32:35], s3 offen offset:256 nt
    s_barrier
    s_waitcnt lgkmcnt(0)
    v_cmp_gt_u32 vcc, 4, v8
    s_nop 1
    s_cbranch_vccnz L_fb_h3
L_fb_h3_ret:
    ds_read_b64_tr_b16 a[152:153], v5 offset:18432
    ds_read_b64_tr_b16 a[154:155], v5 offset:18944
    s_add_u32 m0, s85, 28672
    s_add_u32 s100, s91, 0
    s_add_u32 s100, s100, s101
    buffer_load_dwordx4 v2, s[40:43], s100 offen  lds
    ds_read_b64_tr_b16 a[156:157], v5 offset:18464
    ds_read_b64_tr_b16 a[158:159], v5 offset:18976
    v_and_b32 v24, v20, v34
    v_and_b32 v25, v21, v34
    v_and_b32 v26, v22, v34
    v_and_b32 v27, v23, v34
    s_nop 1
    v_mfma_f32_16x16x32_bf16 v[160:163], v[24:27], v[88:91], v[160:163]
    v_mfma_f32_16x16x32_bf16 v[164:167], v[24:27], v[92:95], v[164:167]
    v_mfma_f32_16x16x32_bf16 v[168:171], v[24:27], v[96:99], v[168:171]
    v_and_b32 v28, v20, v35
    v_and_b32 v29, v21, v35
    v_and_b32 v30, v22, v35
    v_and_b32 v31, v23, v35
    s_nop 1
    v_mfma_f32_16x16x32_bf16 v[160:163], v[28:31], v[100:103], v[160:163]
    v_mfma_f32_16x16x32_bf16 v[164:167], v[28:31], v[104:107], v[164:167]
    v_mfma_f32_16x16x32_bf16 v[168:171], v[28:31], v[108:111], v[168:171]
    s_add_u32 m0, s85, 22528
    s_add_u32 s100, s90, 20480
    s_add_u32 s100, s100, s101
    buffer_load_dwordx4 v2, s[40:43], s100 offen  lds
    s_waitcnt vmcnt(7)
    s_add_u32 s3, s80, 43008
    buffer_load_dwordx4 v[148:151], v1, s[32:35], s3 offen offset:0 nt
    buffer_load_dwordx4 v[152:155], v1, s[32:35], s3 offen offset:128 nt
    buffer_load_dwordx4 v[156:159], v1, s[32:35], s3 offen offset:256 nt
    s_barrier
    v_add_u32 v19, 1, v19
    buffer_store_dword v19, v18, s[48:51], s20 offen
    s_add_u32 s24, s0, 10
    v_subrev_u32 v14, s24, v14
    v_cmp_gt_u32 s[68:69], 64, v14
    s_xor_b32 s24, s21, 29
    s_bitcmp1_b32 s68, s24
    s_cbranch_scc1 L_nh9_0
    s_xor_b32 s24, s25, 753
    s_mul_i32 s24, s24, 393216
    s_add_u32 s24, s24, 43008
    buffer_load_dword a240, v16, s[32:35], s24 offen nt
    buffer_load_dword a240, v16, s[32:35], s24 offen
    s_branch L_nh9
L_nh9_0:
    s_xor_b32 s24, s21, 31
    s_bitcmp1_b32 s68, s24
    s_cbranch_scc1 L_nh9_1
    s_xor_b32 s24, s25, 1009
    s_mul_i32 s24, s24, 393216
    s_add_u32 s24, s24, 49152
    buffer_load_dword a240, v16, s[32:35], s24 offen nt
    buffer_load_dword a240, v16, s[32:35], s24 offen
    s_branch L_nh9
L_nh9_1:
    s_xor_b32 s24, s21, 15
    s_bitcmp1_b32 s68, s24
    s_cbranch_scc1 L_nh9
    s_xor_b32 s24, s25, 849
    s_mul_i32 s24, s24, 393216
    s_add_u32 s24, s24, 55296
    buffer_load_dword a240, v16, s[32:35], s24 offen nt
    buffer_load_dword a240, v16, s[32:35], s24 offen
L_nh9:
    buffer_load_dword v6, v15, s[48:51], s23 offen sc1
    v_and_b32 v24, v20, v36
    v_and_b32 v25, v21, v36
    v_and_b32 v26, v22, v36
    v_and_b32 v27, v23, v36
    s_nop 1
    v_mfma_f32_16x16x32_bf16 v[160:163], v[24:27], v[112:115], v[160:163]
    v_mfma_f32_16x16x32_bf16 v[164:167], v[24:27], v[116:119], v[164:167]
    v_mfma_f32_16x16x32_bf16 v[168:171], v[24:27], v[120:123], v[168:171]
    s_add_u32 m0, s85, 26624
    s_add_u32 s100, s90, 20608
    s_add_u32 s100, s100, s101
    buffer_load_dwordx4 v2, s[40:43], s100 offen  lds
    s_waitcnt vmcnt(9)
    s_add_u32 s3, s80, 49152
    buffer_load_dwordx4 v[64:67], v1, s[32:35], s3 offen offset:0 nt
    buffer_load_dwordx4 v[68:71], v1, s[32:35], s3 offen offset:128 nt
    buffer_load_dwordx4 v[72:75], v1, s[32:35], s3 offen offset:256 nt
    s_barrier
    v_and_b32 v28, v20, v37
    v_and_b32 v29, v21, v37
    v_and_b32 v30, v22, v37
    v_and_b32 v31, v23, v37
    s_nop 1
    v_mfma_f32_16x16x32_bf16 v[160:163], v[28:31], v[124:127], v[160:163]
    v_mfma_f32_16x16x32_bf16 v[164:167], v[28:31], v[128:131], v[164:167]
    v_mfma_f32_16x16x32_bf16 v[168:171], v[28:31], v[132:135], v[168:171]
    s_add_u32 m0, s85, 23552
    s_add_u32 s100, s90, 30720
    s_add_u32 s100, s100, s101
    buffer_load_dwordx4 v2, s[40:43], s100 offen  lds
    s_waitcnt vmcnt(8)
    s_add_u32 s3, s80, 55296
    buffer_load_dwordx4 v[76:79], v1, s[32:35], s3 offen offset:0 nt
    buffer_load_dwordx4 v[80:83], v1, s[32:35], s3 offen offset:128 nt
    buffer_load_dwordx4 v[84:87], v1, s[32:35], s3 offen offset:256 nt
    s_barrier
    v_and_b32 v24, v20, v38
    v_and_b32 v25, v21, v38
    v_and_b32 v26, v22, v38
    v_and_b32 v27, v23, v38
    s_nop 1
    v_mfma_f32_16x16x32_bf16 v[160:163], v[24:27], v[136:139], v[160:163]
    v_mfma_f32_16x16x32_bf16 v[164:167], v[24:27], v[140:143], v[164:167]
    v_mfma_f32_16x16x32_bf16 v[168:171], v[24:27], v[144:147], v[168:171]
    s_add_u32 m0, s85, 27648
    s_add_u32 s100, s90, 30848
    s_add_u32 s100, s100, s101
    buffer_load_dwordx4 v2, s[40:43], s100 offen  lds
    s_waitcnt vmcnt(6)
    s_add_u32 s3, s54, 61440
    buffer_load_dwordx4 v[88:91], v1, s[32:35], s3 offen offset:0 nt
    buffer_load_dwordx4 v[92:95], v1, s[32:35], s3 offen offset:128 nt
    buffer_load_dwordx4 v[96:99], v1, s[32:35], s3 offen offset:256 nt
    s_barrier
    v_add_u32 v19, 1, v19
    buffer_store_dword v19, v18, s[48:51], s20 offen
    s_add_u32 s24, s0, 11
    v_subrev_u32 v6, s24, v6
    v_cmp_gt_u32 s[68:69], 64, v6
    s_xor_b32 s24, s21, 3
    s_bitcmp1_b32 s68, s24
    s_cbranch_scc1 L_nh10_0
    s_xor_b32 s24, s25, 257
    s_mul_i32 s24, s24, 393216
    s_sub_u32 s22, s54, s80
    s_add_u32 s24, s24, s22
    s_add_u32 s24, s24, 61440
    buffer_load_dword a240, v16, s[32:35], s24 offen nt
    buffer_load_dword a240, v16, s[32:35], s24 offen
    s_branch L_nh10
L_nh10_0:
    s_xor_b32 s24, s21, 16
    s_bitcmp1_b32 s68, s24
    s_cbranch_scc1 L_nh10_1
    s_xor_b32 s24, s25, 160
    s_mul_i32 s24, s24, 393216
    s_add_u32 s24, s24, 133632
    buffer_load_dword a240, v16, s[32:35], s24 offen nt
    buffer_load_dword a240, v16, s[32:35], s24 offen
    s_branch L_nh10
L_nh10_1:
    s_xor_b32 s24, s21, 9
    s_bitcmp1_b32 s68, s24
    s_cbranch_scc1 L_nh10
    s_xor_b32 s24, s25, 81
    s_mul_i32 s24, s24, 393216
    s_add_u32 s24, s24, 139776
    buffer_load_dword a240, v16, s[32:35], s24 offen nt
    buffer_load_dword a240, v16, s[32:35], s24 offen
L_nh10:
    buffer_load_dword v14, v15, s[48:51], s23 offen sc1
    v_and_b32 v28, v20, v39
    v_and_b32 v29, v21, v39
    v_and_b32 v30, v22, v39
    v_and_b32 v31, v23, v39
    s_nop 1
    v_mfma_f32_16x16x32_bf16 v[160:163], v[28:31], v[148:151], v[160:163]
    v_mfma_f32_16x16x32_bf16 v[164:167], v[28:31], v[152:155], v[164:167]
    v_mfma_f32_16x16x32_bf16 v[168:171], v[28:31], v[156:159], v[168:171]
    s_add_u32 m0, s85, 29696
    s_add_u32 s100, s91, 10240
    s_add_u32 s100, s100, s101
    buffer_load_dwordx4 v2, s[40:43], s100 offen  lds
    s_waitcnt vmcnt(8)
    s_add_u32 s3, s80, 133632
    buffer_load_dwordx4 v[100:103], v1, s[32:35], s3 offen offset:0 nt
    buffer_load_dwordx4 v[104:107], v1, s[32:35], s3 offen offset:128 nt
    buffer_load_dwordx4 v[108:111], v1, s[32:35], s3 offen offset:256 nt
    s_barrier
    v_and_b32 v24, v20, v40
    v_and_b32 v25, v21, v40
    v_and_b32 v26, v22, v40
    v_and_b32 v27, v23, v40
    s_nop 1
    v_mfma_f32_16x16x32_bf16 v[160:163], v[24:27], v[64:67], v[160:163]
    v_mfma_f32_16x16x32_bf16 v[164:167], v[24:27], v[68:71], v[164:167]
    v_mfma_f32_16x16x32_bf16 v[168:171], v[24:27], v[72:75], v[168:171]
    s_add_u32 m0, s85, 0
    s_add_u32 s100, s90, 163840
    buffer_load_dwordx4 v2, s[36:39], s100 offen  lds
    s_waitcnt vmcnt(8)
    s_add_u32 s3, s80, 139776
    buffer_load_dwordx4 v[112:115], v1, s[32:35], s3 offen offset:0 nt
    buffer_load_dwordx4 v[116:119], v1, s[32:35], s3 offen offset:128 nt
    buffer_load_dwordx4 v[120:123], v1, s[32:35], s3 offen offset:256 nt
    s_barrier
    v_and_b32 v28, v20, v41
    v_and_b32 v29, v21, v41
    v_and_b32 v30, v22, v41
    v_and_b32 v31, v23, v41
    s_nop 1
    v_mfma_f32_16x16x32_bf16 v[160:163], v[28:31], v[76:79], v[160:163]
    v_mfma_f32_16x16x32_bf16 v[164:167], v[28:31], v[80:83], v[164:167]
    v_mfma_f32_16x16x32_bf16 v[168:171], v[28:31], v[84:87], v[168:171]
    s_add_u32 m0, s85, 4096
    s_add_u32 s100, s90, 163968
    buffer_load_dwordx4 v2, s[36:39], s100 offen  lds
    s_add_u32 m0, s85, 1024
    s_add_u32 s100, s90, 174080
    buffer_load_dwordx4 v2, s[36:39], s100 offen  lds
    s_waitcnt vmcnt(7)
    s_add_u32 s3, s80, 145920
    buffer_load_dwordx4 v[124:127], v1, s[32:35], s3 offen offset:0 nt
    buffer_load_dwordx4 v[128:131], v1, s[32:35], s3 offen offset:128 nt
    buffer_load_dwordx4 v[132:135], v1, s[32:35], s3 offen offset:256 nt
    s_barrier
    v_add_u32 v19, 1, v19
    buffer_store_dword v19, v18, s[48:51], s20 offen
    s_add_u32 s24, s0, 12
    v_subrev_u32 v14, s24, v14
    v_cmp_gt_u32 s[68:69], 64, v14
    s_xor_b32 s24, s21, 8
    s_bitcmp1_b32 s68, s24
    s_cbranch_scc1 L_nh11_0
    s_xor_b32 s24, s25, 80
    s_mul_i32 s24, s24, 393216
    s_add_u32 s24, s24, 145920
    buffer_load_dword a240, v16, s[32:35], s24 offen nt
    buffer_load_dword a240, v16, s[32:35], s24 offen
    s_branch L_nh11
L_nh11_0:
    s_xor_b32 s24, s21, 5
    s_bitcmp1_b32 s68, s24
    s_cbranch_scc1 L_nh11_1
    s_xor_b32 s24, s25, 513
    s_mul_i32 s24, s24, 393216
    s_add_u32 s24, s24, 152064
    buffer_load_dword a240, v16, s[32:35], s24 offen nt
    buffer_load_dword a240, v16, s[32:35], s24 offen
    s_branch L_nh11
L_nh11_1:
    s_xor_b32 s24, s21, 4
    s_bitcmp1_b32 s68, s24
    s_cbranch_scc1 L_nh11
    s_xor_b32 s24, s25, 512
    s_mul_i32 s24, s24, 393216
    s_add_u32 s24, s24, 158208
    buffer_load_dword a240, v16, s[32:35], s24 offen nt
    buffer_load_dword a240, v16, s[32:35], s24 offen
L_nh11:
    buffer_load_dword v6, v15, s[48:51], s23 offen sc1
    v_and_b32 v24, v20, v42
    v_and_b32 v25, v21, v42
    v_and_b32 v26, v22, v42
    v_and_b32 v27, v23, v42
    s_nop 1
    v_mfma_f32_16x16x32_bf16 v[160:163], v[24:27], v[88:91], v[160:163]
    v_mfma_f32_16x16x32_bf16 v[164:167], v[24:27], v[92:95], v[164:167]
    v_mfma_f32_16x16x32_bf16 v[168:171], v[24:27], v[96:99], v[168:171]
    s_waitcnt lgkmcnt(0)
    v_xor_b32 v8, 4, v3
    v_mov_b32 v9, 5
    ds_write_b32 v8, v9
    v_lshrrev_b32 v8, 4, v0
    v_lshlrev_b32 v9, 5, v8
    v_add_u32 v9, 138368, v9
    ds_read_b128 v[236:239], v9 offset:0
    ds_read_b128 v[240:243], v9 offset:16
    ds_read_b128 v[244:247], v9 offset:96
    ds_read_b128 v[248:251], v9 offset:112
    ds_read_b128 v[172:175], v9 offset:1024
    ds_read_b128 v[176:179], v9 offset:1040
    ds_read_b128 v[180:183], v9 offset:1120
    ds_read_b128 v[184:187], v9 offset:1136
    s_add_u32 m0, s85, 5120
    s_add_u32 s100, s90, 174208
    buffer_load_dwordx4 v2, s[36:39], s100 offen  lds
    ds_read_b128 v[188:191], v9 offset:2048
    ds_read_b128 v[192:195], v9 offset:2064
    ds_read_b128 v[196:199], v9 offset:2144
    ds_read_b128 v[200:203], v9 offset:2160
    ds_read_b128 v[216:219], v9 offset:3072
    ds_read_b128 v[220:223], v9 offset:3088
    ds_read_b128 v[224:227], v9 offset:3168
    ds_read_b128 v[228:231], v9 offset:3184
    v_and_b32 v9, 7, v0
    v_cmp_eq_u32 vcc, 0, v9
    v_cmp_gt_u32 s[96:97], 3, v8
    s_nop 0
    s_and_b64 s[96:97], s[96:97], vcc
    s_mov_b32 s81, 0xbfb8aa3b
    s_waitcnt vmcnt(9)
    s_add_u32 s3, s80, 152064
    buffer_load_dwordx4 v[136:139], v1, s[32:35], s3 offen offset:0 nt
    buffer_load_dwordx4 v[140:143], v1, s[32:35], s3 offen offset:128 nt
    buffer_load_dwordx4 v[144:147], v1, s[32:35], s3 offen offset:256 nt
    s_barrier
    s_waitcnt lgkmcnt(0)
    v_pk_add_f32 v[236:237], v[236:237], v[172:173]
    v_pk_add_f32 v[238:239], v[238:239], v[174:175]
    v_pk_add_f32 v[240:241], v[240:241], v[176:177]
    v_pk_add_f32 v[242:243], v[242:243], v[178:179]
    v_pk_add_f32 v[244:245], v[244:245], v[180:181]
    v_pk_add_f32 v[246:247], v[246:247], v[182:183]
    v_pk_add_f32 v[248:249], v[248:249], v[184:185]
    v_pk_add_f32 v[250:251], v[250:251], v[186:187]
    v_pk_add_f32 v[188:189], v[188:189], v[216:217]
    v_pk_add_f32 v[190:191], v[190:191], v[218:219]
    v_pk_add_f32 v[192:193], v[192:193], v[220:221]
    v_pk_add_f32 v[194:195], v[194:195], v[222:223]
    v_pk_add_f32 v[196:197], v[196:197], v[224:225]
    v_pk_add_f32 v[198:199], v[198:199], v[226:227]
    v_pk_add_f32 v[200:201], v[200:201], v[228:229]
    v_pk_add_f32 v[202:203], v[202:203], v[230:231]
    v_pk_add_f32 v[236:237], v[236:237], v[188:189]
    v_pk_add_f32 v[238:239], v[238:239], v[190:191]
    v_pk_add_f32 v[240:241], v[240:241], v[192:193]
    v_pk_add_f32 v[242:243], v[242:243], v[194:195]
    v_pk_add_f32 v[244:245], v[244:245], v[196:197]
    v_pk_add_f32 v[246:247], v[246:247], v[198:199]
    v_pk_add_f32 v[248:249], v[248:249], v[200:201]
    v_pk_add_f32 v[250:251], v[250:251], v[202:203]
    v_cvt_pk_bf16_f32 v12, v236, v237
    v_cvt_pk_bf16_f32 v13, v244, v245
    v_lshlrev_b32 v8, 16, v12
    v_and_b32 v9, 0xffff0000, v12
    v_mul_f32 v10, s81, v8
    v_mul_f32 v11, s81, v9
    v_exp_f32 v10, v10
    v_exp_f32 v11, v11
    v_add_f32 v10, 1.0, v10
    v_add_f32 v11, 1.0, v11
    v_rcp_f32 v10, v10
    v_rcp_f32 v11, v11
    v_mul_f32 v8, v8, v10
    v_mul_f32 v9, v9, v11
    v_cvt_pk_bf16_f32 v10, v8, v9
    v_lshlrev_b32 v8, 16, v10
    v_and_b32 v9, 0xffff0000, v10
    v_lshlrev_b32 v10, 16, v13
    v_and_b32 v11, 0xffff0000, v13
    v_mul_f32 v8, v8, v10
    v_mul_f32 v9, v9, v11
    v_cvt_pk_bf16_f32 v10, v8, v9
    v_cndmask_b32 v212, 0, v10, s[96:97]
    s_add_u32 m0, s85, 8192
    s_add_u32 s100, s91, 163840
    buffer_load_dwordx4 v2, s[36:39], s100 offen  lds
    v_cvt_pk_bf16_f32 v12, v238, v239
    v_cvt_pk_bf16_f32 v13, v246, v247
    v_lshlrev_b32 v8, 16, v12
    v_and_b32 v9, 0xffff0000, v12
    v_mul_f32 v10, s81, v8
    v_mul_f32 v11, s81, v9
    v_exp_f32 v10, v10
    v_exp_f32 v11, v11
    v_add_f32 v10, 1.0, v10
    v_add_f32 v11, 1.0, v11
    v_rcp_f32 v10, v10
    v_rcp_f32 v11, v11
    v_mul_f32 v8, v8, v10
    v_mul_f32 v9, v9, v11
    v_cvt_pk_bf16_f32 v10, v8, v9
    v_lshlrev_b32 v8, 16, v10
    v_and_b32 v9, 0xffff0000, v10
    v_lshlrev_b32 v10, 16, v13
    v_and_b32 v11, 0xffff0000, v13
    v_mul_f32 v8, v8, v10
    v_mul_f32 v9, v9, v11
    v_cvt_pk_bf16_f32 v10, v8, v9
    v_cndmask_b32 v213, 0, v10, s[96:97]
    s_waitcnt vmcnt(8)
    s_add_u32 s3, s80, 158208
    buffer_load_dwordx4 v[148:151], v1, s[32:35], s3 offen offset:0 nt
    buffer_load_dwordx4 v[152:155], v1, s[32:35], s3 offen offset:128 nt
    buffer_load_dwordx4 v[156:159], v1, s[32:35], s3 offen offset:256 nt
    s_barrier
    v_cvt_pk_bf16_f32 v12, v240, v241
    v_cvt_pk_bf16_f32 v13, v248, v249
    v_lshlrev_b32 v8, 16, v12
    v_and_b32 v9, 0xffff0000, v12
    v_mul_f32 v10, s81, v8
    v_mul_f32 v11, s81, v9
    v_exp_f32 v10, v10
    v_exp_f32 v11, v11
    v_add_f32 v10, 1.0, v10
    v_add_f32 v11, 1.0, v11
    v_rcp_f32 v10, v10
    v_rcp_f32 v11, v11
    v_mul_f32 v8, v8, v10
    v_mul_f32 v9, v9, v11
    v_cvt_pk_bf16_f32 v10, v8, v9
    v_lshlrev_b32 v8, 16, v10
    v_and_b32 v9, 0xffff0000, v10
    v_lshlrev_b32 v10, 16, v13
    v_and_b32 v11, 0xffff0000, v13
    v_mul_f32 v8, v8, v10
    v_mul_f32 v9, v9, v11
    v_cvt_pk_bf16_f32 v10, v8, v9
    v_cndmask_b32 v214, 0, v10, s[96:97]
    s_add_u32 m0, s85, 2048
    s_add_u32 s100, s90, 184320
    buffer_load_dwordx4 v2, s[36:39], s100 offen  lds
    v_cvt_pk_bf16_f32 v12, v242, v243
    v_cvt_pk_bf16_f32 v13, v250, v251
    v_lshlrev_b32 v8, 16, v12
    v_and_b32 v9, 0xffff0000, v12
    v_mul_f32 v10, s81, v8
    v_mul_f32 v11, s81, v9
    v_exp_f32 v10, v10
    v_exp_f32 v11, v11
    v_add_f32 v10, 1.0, v10
    v_add_f32 v11, 1.0, v11
    v_rcp_f32 v10, v10
    v_rcp_f32 v11, v11
    v_mul_f32 v8, v8, v10
    v_mul_f32 v9, v9, v11
    v_cvt_pk_bf16_f32 v10, v8, v9
    v_lshlrev_b32 v8, 16, v10
    v_and_b32 v9, 0xffff0000, v10
    v_lshlrev_b32 v10, 16, v13
    v_and_b32 v11, 0xffff0000, v13
    v_mul_f32 v8, v8, v10
    v_mul_f32 v9, v9, v11
    v_cvt_pk_bf16_f32 v10, v8, v9
    v_cndmask_b32 v215, 0, v10, s[96:97]
    s_waitcnt vmcnt(6)
    s_add_u32 s3, s80, 164352
    buffer_load_dwordx4 v[64:67], v1, s[32:35], s3 offen offset:0 nt
    buffer_load_dwordx4 v[68:71], v1, s[32:35], s3 offen offset:128 nt
    buffer_load_dwordx4 v[72:75], v1, s[32:35], s3 offen offset:256 nt
    s_barrier
    v_add_u32 v19, 1, v19
    buffer_store_dword v19, v18, s[48:51], s20 offen
    s_add_u32 s24, s0, 13
    v_subrev_u32 v6, s24, v6
    v_cmp_gt_u32 s[68:69], 64, v6
    s_xor_b32 s24, s21, 18
    s_bitcmp1_b32 s68, s24
    s_cbranch_scc1 L_nh12_0
    s_xor_b32 s24, s25, 416
    s_mul_i32 s24, s24, 393216
    s_add_u32 s24, s24, 164352
    buffer_load_dword a240, v16, s[32:35], s24 offen nt
    buffer_load_dword a240, v16, s[32:35], s24 offen
    s_branch L_nh12
L_nh12_0:
    s_xor_b32 s24, s21, 2
    s_bitcmp1_b32 s68, s24
    s_cbranch_scc1 L_nh12_1
    s_xor_b32 s24, s25, 256
    s_mul_i32 s24, s24, 393216
    s_add_u32 s24, s24, 170496
    buffer_load_dword a240, v16, s[32:35], s24 offen nt
    buffer_load_dword a240, v16, s[32:35], s24 offen
    s_branch L_nh12
L_nh12_1:
    s_xor_b32 s24, s21, 28
    s_bitcmp1_b32 s68, s24
    s_cbranch_scc1 L_nh12
    s_xor_b32 s24, s25, 752
    s_mul_i32 s24, s24, 393216
    s_add_u32 s24, s24, 176640
    buffer_load_dword a240, v16, s[32:35], s24 offen nt
    buffer_load_dword a240, v16, s[32:35], s24 offen
L_nh12:
    buffer_load_dword v14, v15, s[48:51], s23 offen sc1
    ds_read_b64_tr_b16 v[216:217], v4 offset:20480
    ds_read_b64_tr_b16 v[218:219], v4 offset:20992
    ds_read_b64_tr_b16 v[220:221], v4 offset:20512
    ds_read_b64_tr_b16 v[222:223], v4 offset:21024
    ds_read_b64_tr_b16 v[224:225], v4 offset:20544
    ds_read_b64_tr_b16 v[226:227], v4 offset:21056
    ds_read_b64_tr_b16 v[228:229], v4 offset:20576
    ds_read_b64_tr_b16 v[230:231], v4 offset:21088
    ds_read_b64_tr_b16 v[232:233], v4 offset:24576
    ds_read_b64_tr_b16 v[234:235], v4 offset:25088
    s_add_u32 m0, s85, 6144
    s_add_u32 s100, s90, 184448
    buffer_load_dwordx4 v2, s[36:39], s100 offen  lds
    s_waitcnt lgkmcnt(8)
    v_mfma_f32_16x16x32_bf16 v[172:175], v[212:215], v[216:219], 0
    s_waitcnt lgkmcnt(6)
    v_mfma_f32_16x16x32_bf16 v[176:179], v[212:215], v[220:223], 0
    s_waitcnt lgkmcnt(4)
    v_mfma_f32_16x16x32_bf16 v[180:183], v[212:215], v[224:227], 0
    s_waitcnt lgkmcnt(2)
    v_mfma_f32_16x16x32_bf16 v[184:187], v[212:215], v[228:231], 0
    s_waitcnt lgkmcnt(0)
    v_mfma_f32_16x16x32_bf16 v[188:191], v[212:215], v[232:235], 0
    s_nop 7
    s_waitcnt vmcnt(8)
    s_add_u32 s3, s80, 170496
    buffer_load_dwordx4 v[76:79], v1, s[32:35], s3 offen offset:0 nt
    buffer_load_dwordx4 v[80:83], v1, s[32:35], s3 offen offset:128 nt
    buffer_load_dwordx4 v[84:87], v1, s[32:35], s3 offen offset:256 nt
    s_barrier
    s_add_u32 m0, s85, 3072
    s_add_u32 s100, s90, 194560
    buffer_load_dwordx4 v2, s[36:39], s100 offen  lds
    ds_read_b32 v8, v3
    s_waitcnt vmcnt(8)
    s_add_u32 s3, s80, 176640
    buffer_load_dwordx4 v[88:91], v1, s[32:35], s3 offen offset:0 nt
    buffer_load_dwordx4 v[92:95], v1, s[32:35], s3 offen offset:128 nt
    buffer_load_dwordx4 v[96:99], v1, s[32:35], s3 offen offset:256 nt
    s_barrier
    s_waitcnt lgkmcnt(0)
    v_cmp_gt_u32 vcc, 5, v8
    s_nop 1
    s_cbranch_vccnz L_fb_h4
L_fb_h4_ret:
    ds_read_b64_tr_b16 v[216:217], v4 offset:24608
    ds_read_b64_tr_b16 v[218:219], v4 offset:25120
    ds_read_b64_tr_b16 v[220:221], v4 offset:24640
    ds_read_b64_tr_b16 v[222:223], v4 offset:25152
    ds_read_b64_tr_b16 v[224:225], v4 offset:24672
    ds_read_b64_tr_b16 v[226:227], v4 offset:25184
    ds_read_b64_tr_b16 v[228:229], v5 offset:28672
    ds_read_b64_tr_b16 v[230:231], v5 offset:29184
    ds_read_b64_tr_b16 v[232:233], v5 offset:28704
    ds_read_b64_tr_b16 v[234:235], v5 offset:29216
    s_add_u32 m0, s85, 7168
    s_add_u32 s100, s90, 194688
    buffer_load_dwordx4 v2, s[36:39], s100 offen  lds
    s_waitcnt lgkmcnt(8)
    v_mfma_f32_16x16x32_bf16 v[192:195], v[212:215], v[216:219], 0
    s_waitcnt lgkmcnt(6)
    v_mfma_f32_16x16x32_bf16 v[196:199], v[212:215], v[220:223], 0
    s_waitcnt lgkmcnt(4)
    v_mfma_f32_16x16x32_bf16 v[200:203], v[212:215], v[224:227], 0
    s_waitcnt lgkmcnt(2)
    v_mfma_f32_16x16x32_bf16 v[204:207], v[212:215], v[228:231], 0
    s_waitcnt lgkmcnt(0)
    v_mfma_f32_16x16x32_bf16 v[208:211], v[212:215], v[232:235], 0
    s_nop 7
    s_add_u32 m0, s85, 9216
    s_add_u32 s100, s91, 174080
    buffer_load_dwordx4 v2, s[36:39], s100 offen  lds
    v_and_b32 v28, v20, v43
    v_and_b32 v29, v21, v43
    v_and_b32 v30, v22, v43
    v_and_b32 v31, v23, v43
    s_nop 1
    v_mfma_f32_16x16x32_bf16 v[160:163], v[28:31], v[100:103], v[160:163]
    v_mfma_f32_16x16x32_bf16 v[164:167], v[28:31], v[104:107], v[164:167]
    v_mfma_f32_16x16x32_bf16 v[168:171], v[28:31], v[108:111], v[168:171]
    v_and_b32 v24, v20, v44
    v_and_b32 v25, v21, v44
    v_and_b32 v26, v22, v44
    v_and_b32 v27, v23, v44
    s_nop 1
    v_mfma_f32_16x16x32_bf16 v[160:163], v[24:27], v[112:115], v[160:163]
    v_mfma_f32_16x16x32_bf16 v[164:167], v[24:27], v[116:119], v[164:167]
    v_mfma_f32_16x16x32_bf16 v[168:171], v[24:27], v[120:123], v[168:171]
    v_and_b32 v28, v20, v45
    v_and_b32 v29, v21, v45
    v_and_b32 v30, v22, v45
    v_and_b32 v31, v23, v45
    s_nop 1
    v_mfma_f32_16x16x32_bf16 v[160:163], v[28:31], v[124:127], v[160:163]
    v_mfma_f32_16x16x32_bf16 v[164:167], v[28:31], v[128:131], v[164:167]
    v_mfma_f32_16x16x32_bf16 v[168:171], v[28:31], v[132:135], v[168:171]
    v_and_b32 v24, v20, v46
    v_and_b32 v25, v21, v46
    v_and_b32 v26, v22, v46
    v_and_b32 v27, v23, v46
    s_nop 1
    v_mfma_f32_16x16x32_bf16 v[160:163], v[24:27], v[136:139], v[160:163]
    v_mfma_f32_16x16x32_bf16 v[164:167], v[24:27], v[140:143], v[164:167]
    v_mfma_f32_16x16x32_bf16 v[168:171], v[24:27], v[144:147], v[168:171]
    v_and_b32 v28, v20, v47
    v_and_b32 v29, v21, v47
    v_and_b32 v30, v22, v47
    v_and_b32 v31, v23, v47
    s_nop 1
    v_mfma_f32_16x16x32_bf16 v[160:163], v[28:31], v[148:151], v[160:163]
    v_mfma_f32_16x16x32_bf16 v[164:167], v[28:31], v[152:155], v[164:167]
    v_mfma_f32_16x16x32_bf16 v[168:171], v[28:31], v[156:159], v[168:171]
    v_and_b32 v8, 7, v0
    v_lshlrev_b32 v245, 4, v8
    buffer_load_dwordx4 v[246:249], v245, s[48:51], s93 offen sc1
    v_bfe_u32 v9, v0, 4, 1
    v_lshrrev_b32 v10, 5, v0
    v_lshl_add_u32 v9, v9, 1, v10
    v_lshl_add_u32 v9, v8, 2, v9
    v_lshlrev_b32 v254, 1, v9
    s_lshr_b32 s57, s2, 1
    s_sub_u32 s57, 127, s57
    s_bitcmp1_b32 s2, 0
    s_cselect_b32 s57, s57, 255
    s_lshl_b32 s81, s57, 6
    buffer_load_ushort v250, v254, s[44:47], s81 offen
    v_lshlrev_b32 v253, 2, v0
    s_waitcnt vmcnt(9)
    s_add_u32 s3, s80, 182784
    buffer_load_dwordx4 v[100:103], v1, s[32:35], s3 offen offset:0 nt
    buffer_load_dwordx4 v[104:107], v1, s[32:35], s3 offen offset:128 nt
    buffer_load_dwordx4 v[108:111], v1, s[32:35], s3 offen offset:256 nt
    s_barrier
    v_add_u32 v19, 1, v19
    buffer_store_dword v19, v18, s[48:51], s20 offen
    s_add_u32 s24, s0, 14
    v_subrev_u32 v14, s24, v14
    v_cmp_gt_u32 s[68:69], 64, v14
    s_xor_b32 s24, s21, 21
    s_bitcmp1_b32 s68, s24
    s_cbranch_scc1 L_nh13_0
    s_xor_b32 s24, s25, 673
    s_mul_i32 s24, s24, 393216
    s_add_u32 s24, s24, 182784
    buffer_load_dword a240, v16, s[32:35], s24 offen nt
    buffer_load_dword a240, v16, s[32:35], s24 offen
    s_branch L_nh13
L_nh13_0:
    s_xor_b32 s24, s21, 10
    s_bitcmp1_b32 s68, s24
    s_cbranch_scc1 L_nh13_1
    s_xor_b32 s24, s25, 336
    s_mul_i32 s24, s24, 393216
    s_add_u32 s24, s24, 188928
    buffer_load_dword a240, v16, s[32:35], s24 offen nt
    buffer_load_dword a240, v16, s[32:35], s24 offen
    s_branch L_nh13
L_nh13_1:
    s_xor_b32 s24, s21, 7
    s_bitcmp1_b32 s68, s24
    s_cbranch_scc1 L_nh13
    s_xor_b32 s24, s25, 769
    s_mul_i32 s24, s24, 393216
    s_sub_u32 s22, s55, s80
    s_add_u32 s24, s24, s22
    s_add_u32 s24, s24, 129024
    buffer_load_dword a240, v16, s[32:35], s24 offen nt
    buffer_load_dword a240, v16, s[32:35], s24 offen
L_nh13:
    buffer_load_dword v6, v15, s[48:51], s23 offen sc1
    v_and_b32 v24, v20, v48
    v_and_b32 v25, v21, v48
    v_and_b32 v26, v22, v48
    v_and_b32 v27, v23, v48
    s_nop 1
    v_mfma_f32_16x16x32_bf16 v[160:163], v[24:27], v[64:67], v[160:163]
    v_mfma_f32_16x16x32_bf16 v[164:167], v[24:27], v[68:71], v[164:167]
    v_mfma_f32_16x16x32_bf16 v[168:171], v[24:27], v[72:75], v[168:171]
    s_add_u32 m0, s85, 10240
    s_add_u32 s100, s90, 204800
    buffer_load_dwordx4 v2, s[36:39], s100 offen  lds
    s_waitcnt vmcnt(11)
    s_add_u32 s3, s80, 188928
    buffer_load_dwordx4 v[112:115], v1, s[32:35], s3 offen offset:0 nt
    buffer_load_dwordx4 v[116:119], v1, s[32:35], s3 offen offset:128 nt
    buffer_load_dwordx4 v[120:123], v1, s[32:35], s3 offen offset:256 nt
    s_barrier
    v_and_b32 v28, v20, v49
    v_and_b32 v29, v21, v49
    v_and_b32 v30, v22, v49
    v_and_b32 v31, v23, v49
    s_nop 1
    v_mfma_f32_16x16x32_bf16 v[160:163], v[28:31], v[76:79], v[160:163]
    v_mfma_f32_16x16x32_bf16 v[164:167], v[28:31], v[80:83], v[164:167]
    v_mfma_f32_16x16x32_bf16 v[168:171], v[28:31], v[84:87], v[168:171]
    s_add_u32 m0, s85, 14336
    s_add_u32 s100, s90, 204928
    buffer_load_dwordx4 v2, s[36:39], s100 offen  lds
    s_waitcnt vmcnt(8)
    s_add_u32 s3, s55, 129024
    buffer_load_dwordx4 v[124:127], v1, s[32:35], s3 offen offset:0 nt
    buffer_load_dwordx4 v[128:131], v1, s[32:35], s3 offen offset:128 nt
    buffer_load_dwordx4 v[132:135], v1, s[32:35], s3 offen offset:256 nt
    s_barrier
    v_and_b32 v24, v20, v50
    v_and_b32 v25, v21, v50
    v_and_b32 v26, v22, v50
    v_and_b32 v27, v23, v50
    s_nop 1
    v_mfma_f32_16x16x32_bf16 v[160:163], v[24:27], v[88:91], v[160:163]
    v_mfma_f32_16x16x32_bf16 v[164:167], v[24:27], v[92:95], v[164:167]
    v_mfma_f32_16x16x32_bf16 v[168:171], v[24:27], v[96:99], v[168:171]
    v_xor_b32 v8, 4, v3
    v_mov_b32 v9, 6
    ds_write_b32 v8, v9
    ds_read_b64_tr_b16 a[160:161], v4 offset:0
    ds_read_b64_tr_b16 a[162:163], v4 offset:512
    ds_read_b64_tr_b16 a[164:165], v4 offset:32
    ds_read_b64_tr_b16 a[166:167], v4 offset:544
    ds_read_b64_tr_b16 a[168:169], v4 offset:64
    ds_read_b64_tr_b16 a[170:171], v4 offset:576
    s_add_u32 m0, s85, 11264
    s_add_u32 s100, s90, 215040
    buffer_load_dwordx4 v2, s[36:39], s100 offen  lds
    ds_read_b64_tr_b16 a[172:173], v4 offset:96
    ds_read_b64_tr_b16 a[174:175], v4 offset:608
    ds_read_b64_tr_b16 a[176:177], v4 offset:4096
    ds_read_b64_tr_b16 a[178:179], v4 offset:4608
    ds_read_b64_tr_b16 a[180:181], v4 offset:4128
    ds_read_b64_tr_b16 a[182:183], v4 offset:4640
    s_waitcnt vmcnt(6)
    s_add_u32 s3, s80, 267264
    buffer_load_dwordx4 v[136:139], v1, s[32:35], s3 offen offset:0 nt
    buffer_load_dwordx4 v[140:143], v1, s[32:35], s3 offen offset:128 nt
    buffer_load_dwordx4 v[144:147], v1, s[32:35], s3 offen offset:256 nt
    s_barrier
    v_add_u32 v19, 1, v19
    buffer_store_dword v19, v18, s[48:51], s20 offen
    s_add_u32 s24, s0, 15
    v_subrev_u32 v6, s24, v6
    v_cmp_gt_u32 s[68:69], 64, v6
    s_xor_b32 s24, s21, 25
    s_bitcmp1_b32 s68, s24
    s_cbranch_scc1 L_nh14_0
    s_xor_b32 s24, s25, 241
    s_mul_i32 s24, s24, 393216
    s_add_u32 s24, s24, 267264
    buffer_load_dword a240, v16, s[32:35], s24 offen nt
    buffer_load_dword a240, v16, s[32:35], s24 offen
    s_branch L_nh14
L_nh14_0:
    s_xor_b32 s24, s21, 14
    s_bitcmp1_b32 s68, s24
    s_cbranch_scc1 L_nh14_1
    s_xor_b32 s24, s25, 848
    s_mul_i32 s24, s24, 393216
    s_add_u32 s24, s24, 273408
    buffer_load_dword a240, v16, s[32:35], s24 offen nt
    buffer_load_dword a240, v16, s[32:35], s24 offen
    s_branch L_nh14
L_nh14_1:
    s_xor_b32 s24, s21, 19
    s_bitcmp1_b32 s68, s24
    s_cbranch_scc1 L_nh14
    s_xor_b32 s24, s25, 417
    s_mul_i32 s24, s24, 393216
    s_add_u32 s24, s24, 279552
    buffer_load_dword a240, v16, s[32:35], s24 offen nt
    buffer_load_dword a240, v16, s[32:35], s24 offen
L_nh14:
    buffer_load_dword v14, v15, s[48:51], s23 offen sc1
    ds_read_b64_tr_b16 a[184:185], v4 offset:4160
    ds_read_b64_tr_b16 a[186:187], v4 offset:4672
    ds_read_b64_tr_b16 a[188:189], v4 offset:4192
    ds_read_b64_tr_b16 a[190:191], v4 offset:4704
    s_add_u32 m0, s85, 15360
    s_add_u32 s100, s90, 215168
    buffer_load_dwordx4 v2, s[36:39], s100 offen  lds
    ds_read_b32 v8, v3
    s_waitcnt vmcnt(8)
    s_add_u32 s3, s80, 273408
    buffer_load_dwordx4 v[148:151], v1, s[32:35], s3 offen offset:0 nt
    buffer_load_dwordx4 v[152:155], v1, s[32:35], s3 offen offset:128 nt
    buffer_load_dwordx4 v[156:159], v1, s[32:35], s3 offen offset:256 nt
    s_barrier
    s_waitcnt lgkmcnt(0)
    v_cmp_gt_u32 vcc, 6, v8
    s_nop 1
    s_cbranch_vccnz L_fb_h5
L_fb_h5_ret:
    ds_read_b64_tr_b16 a[192:193], v5 offset:8192
    ds_read_b64_tr_b16 a[194:195], v5 offset:8704
    s_add_u32 m0, s85, 18432
    s_add_u32 s100, s91, 204800
    buffer_load_dwordx4 v2, s[36:39], s100 offen  lds
    ds_read_b64_tr_b16 a[196:197], v5 offset:8224
    ds_read_b64_tr_b16 a[198:199], v5 offset:8736
    v_and_b32 v28, v20, v51
    v_and_b32 v29, v21, v51
    v_and_b32 v30, v22, v51
    v_and_b32 v31, v23, v51
    s_nop 1
    v_mfma_f32_16x16x32_bf16 v[160:163], v[28:31], v[100:103], v[160:163]
    v_mfma_f32_16x16x32_bf16 v[164:167], v[28:31], v[104:107], v[164:167]
    v_mfma_f32_16x16x32_bf16 v[168:171], v[28:31], v[108:111], v[168:171]
    v_and_b32 v24, v20, v52
    v_and_b32 v25, v21, v52
    v_and_b32 v26, v22, v52
    v_and_b32 v27, v23, v52
    s_nop 1
    v_mfma_f32_16x16x32_bf16 v[160:163], v[24:27], v[112:115], v[160:163]
    v_mfma_f32_16x16x32_bf16 v[164:167], v[24:27], v[116:119], v[164:167]
    v_mfma_f32_16x16x32_bf16 v[168:171], v[24:27], v[120:123], v[168:171]
    v_xor_b32 v8, s60, v247
    v_bitop3_b32 v8, v249, v8, s60 bitop3:0xde
    v_cmp_ne_u32 vcc, 0, v8
    s_nop 1
    s_cbranch_vccnz L_fb_ml
L_fb_ml_ret:
    v_mov_b32 v8, v246
    s_nop 1
    v_max_f32_dpp v8, v8, v8 quad_perm:[1,0,3,2] row_mask:0xf bank_mask:0xf
    s_nop 1
    v_max_f32_dpp v8, v8, v8 quad_perm:[2,3,0,1] row_mask:0xf bank_mask:0xf
    s_nop 1
    v_max_f32_dpp v8, v8, v8 row_half_mirror row_mask:0xf bank_mask:0xf
    v_sub_f32 v9, v246, v8
    v_sub_f32 v10, v7, v8
    v_exp_f32 v9, v9
    v_exp_f32 v10, v10
    v_mul_f32 v9, v9, v248
    s_nop 1
    v_add_f32_dpp v9, v9, v9 quad_perm:[1,0,3,2] row_mask:0xf bank_mask:0xf
    s_nop 1
    v_add_f32_dpp v9, v9, v9 quad_perm:[2,3,0,1] row_mask:0xf bank_mask:0xf
    s_nop 1
    v_add_f32_dpp v9, v9, v9 row_half_mirror row_mask:0xf bank_mask:0xf
    v_rcp_f32 v9, v9
    v_lshlrev_b32 v250, 16, v250
    v_mul_f32 v244, v10, v9
    s_add_u32 m0, s85, 12288
    s_add_u32 s100, s90, 225280
    buffer_load_dwordx4 v2, s[36:39], s100 offen  lds
    v_mul_f32 v55, v244, v55
    v_mul_f32 v56, v244, v56
    v_mul_f32 v57, v244, v57
    v_mul_f32 v58, v244, v58
    v_mul_f32 v59, v244, v59
    v_mul_f32 v60, v244, v60
    v_mul_f32 v61, v244, v61
    v_mul_f32 v62, v244, v62
    v_mul_f32 v63, v244, v63
    v_cvt_pk_bf16_f32 v55, v55, v55
    v_cvt_pk_bf16_f32 v56, v56, v56
    v_cvt_pk_bf16_f32 v57, v57, v57
    v_cvt_pk_bf16_f32 v58, v58, v58
    v_cvt_pk_bf16_f32 v59, v59, v59
    v_cvt_pk_bf16_f32 v60, v60, v60
    v_cvt_pk_bf16_f32 v61, v61, v61
    v_cvt_pk_bf16_f32 v62, v62, v62
    v_cvt_pk_bf16_f32 v63, v63, v63
    s_waitcnt vmcnt(9)
    s_add_u32 s3, s80, 279552
    buffer_load_dwordx4 v[64:67], v1, s[32:35], s3 offen offset:0 nt
    buffer_load_dwordx4 v[68:71], v1, s[32:35], s3 offen offset:128 nt
    buffer_load_dwordx4 v[72:75], v1, s[32:35], s3 offen offset:256 nt
    s_barrier
    v_bfe_u32 v8, v0, 3, 1
    v_lshrrev_b32 v11, 5, v0
    v_cmp_eq_u32 vcc, v8, v11
    s_lshl_b32 s81, s72, 1
    v_add_u32 v8, s81, v8
    v_mul_u32_u24 v8, 416, v8
    v_and_b32 v9, 7, v0
    v_lshl_add_u32 v8, v9, 4, v8
    v_bfe_u32 v10, v0, 4, 1
    v_lshl_add_u32 v8, v10, 3, v8
    v_add_u32 v8, 122880, v8
    v_lshlrev_b32 v10, 3, v0
    v_add_u32 v10, 126208, v10
    v_cndmask_b32 v251, v10, v8, vcc
    v_mul_u32_u24 v8, 416, v9
    v_lshrrev_b32 v10, 4, v0
    v_lshl_add_u32 v8, v10, 4, v8
    v_add_u32 v252, 122880, v8
    s_add_u32 m0, s85, 16384
    s_add_u32 s100, s90, 225408
    buffer_load_dwordx4 v2, s[36:39], s100 offen  lds
    v_cmp_gt_u32 vcc, 32, v0
    v_mov_b32 v8, 0x7fffffff
    s_nop 0
    v_cndmask_b32 v253, v8, v253, vcc
    v_lshrrev_b32 v8, 3, v0
    v_mul_u32_u24 v8, 2560, v8
    v_lshl_add_u32 v255, v9, 4, v8
    s_mul_i32 s81, s57, 205
    s_lshr_b32 s81, s81, 12
    s_mul_i32 s82, s81, 20
    s_sub_u32 s82, s57, s82
    s_mul_i32 s81, s81, 163840
    s_lshl_b32 s82, s82, 7
    s_add_u32 s81, s81, s82
    s_add_u32 s81, s81, 458752
    s_mul_i32 s82, s72, 40960
    s_add_u32 s81, s81, s82
    s_cmp_lt_u32 s57, 80
    s_cselect_b32 s81, s81, 0x40000000
    v_add_u32 v255, s81, v255
    s_mov_b32 s58, 20480
    s_lshl_b32 s59, s57, 6
    s_and_b32 s61, s60, 63
    s_lshl1_add_u32 s98, s86, s92
    s_lshl1_add_u32 s99, s87, s92
    v_and_b32 v28, v20, v53
    v_and_b32 v29, v21, v53
    v_and_b32 v30, v22, v53
    v_and_b32 v31, v23, v53
    s_nop 1
    v_mfma_f32_16x16x32_bf16 v[160:163], v[28:31], v[124:127], v[160:163]
    v_mfma_f32_16x16x32_bf16 v[164:167], v[28:31], v[128:131], v[164:167]
    v_mfma_f32_16x16x32_bf16 v[168:171], v[28:31], v[132:135], v[168:171]
    s_waitcnt vmcnt(7)
    s_add_u32 s3, s80, 285696
    buffer_load_dwordx4 v[76:79], v1, s[32:35], s3 offen offset:0 nt
    buffer_load_dwordx4 v[80:83], v1, s[32:35], s3 offen offset:128 nt
    buffer_load_dwordx4 v[84:87], v1, s[32:35], s3 offen offset:256 nt
    s_barrier
    s_add_u32 s24, s0, 16
    v_subrev_u32 v14, s24, v14
    v_cmp_gt_u32 s[68:69], 64, v14
    s_xor_b32 s24, s21, 6
    s_bitcmp1_b32 s68, s24
    s_cbranch_scc1 L_nh15_0
    s_xor_b32 s24, s25, 768
    s_mul_i32 s24, s24, 393216
    s_add_u32 s24, s24, 285696
    buffer_load_dword a240, v16, s[32:35], s24 offen nt
    buffer_load_dword a240, v16, s[32:35], s24 offen
    s_branch L_nh15
L_nh15_0:
    s_xor_b32 s24, s21, 27
    s_bitcmp1_b32 s68, s24
    s_cbranch_scc1 L_nh15_1
    s_xor_b32 s24, s25, 497
    s_mul_i32 s24, s24, 393216
    s_add_u32 s24, s24, 291840
    buffer_load_dword a240, v16, s[32:35], s24 offen nt
    buffer_load_dword a240, v16, s[32:35], s24 offen
    s_branch L_nh15
L_nh15_1:
    s_xor_b32 s24, s21, 12
    s_bitcmp1_b32 s68, s24
    s_cbranch_scc1 L_nh15
    s_xor_b32 s24, s25, 592
    s_mul_i32 s24, s24, 393216
    s_add_u32 s24, s24, 297984
    buffer_load_dword a240, v16, s[32:35], s24 offen nt
    buffer_load_dword a240, v16, s[32:35], s24 offen
L_nh15:
    buffer_load_dword v6, v15, s[48:51], s23 offen sc1
    v_and_b32 v24, v20, v54
    v_and_b32 v25, v21, v54
    v_and_b32 v26, v22, v54
    v_and_b32 v27, v23, v54
    s_nop 1
    v_mfma_f32_16x16x32_bf16 v[160:163], v[24:27], v[136:139], v[160:163]
    v_mfma_f32_16x16x32_bf16 v[164:167], v[24:27], v[140:143], v[164:167]
    v_mfma_f32_16x16x32_bf16 v[168:171], v[24:27], v[144:147], v[168:171]
    s_nop 5
    v_mul_f32 v160, v244, v160
    v_mul_f32 v161, v244, v161
    v_mul_f32 v162, v244, v162
    v_mul_f32 v163, v244, v163
    v_mul_f32 v164, v244, v164
    v_mul_f32 v165, v244, v165
    v_mul_f32 v166, v244, v166
    v_mul_f32 v167, v244, v167
    v_mul_f32 v168, v244, v168
    v_mul_f32 v169, v244, v169
    v_mul_f32 v170, v244, v170
    v_mul_f32 v171, v244, v171
    s_add_u32 m0, s85, 13312
    s_add_u32 s100, s90, 235520
    buffer_load_dwordx4 v2, s[36:39], s100 offen  lds
    s_waitcnt vmcnt(7)
    s_add_u32 s3, s80, 291840
    buffer_load_dwordx4 v[88:91], v1, s[32:35], s3 offen offset:0 nt
    buffer_load_dwordx4 v[92:95], v1, s[32:35], s3 offen offset:128 nt
    buffer_load_dwordx4 v[96:99], v1, s[32:35], s3 offen offset:256 nt
    s_barrier
    v_and_b32 v28, v20, v55
    v_and_b32 v29, v21, v55
    v_and_b32 v30, v22, v55
    v_and_b32 v31, v23, v55
    s_nop 1
    v_mfma_f32_16x16x32_bf16 v[160:163], v[28:31], v[148:151], v[160:163]
    v_mfma_f32_16x16x32_bf16 v[164:167], v[28:31], v[152:155], v[164:167]
    v_mfma_f32_16x16x32_bf16 v[168:171], v[28:31], v[156:159], v[168:171]
    s_add_u32 m0, s85, 17408
    s_add_u32 s100, s90, 235648
    buffer_load_dwordx4 v2, s[36:39], s100 offen  lds
    s_waitcnt vmcnt(7)
    s_add_u32 s3, s80, 297984
    buffer_load_dwordx4 v[100:103], v1, s[32:35], s3 offen offset:0 nt
    buffer_load_dwordx4 v[104:107], v1, s[32:35], s3 offen offset:128 nt
    buffer_load_dwordx4 v[108:111], v1, s[32:35], s3 offen offset:256 nt
    s_barrier
    v_and_b32 v24, v20, v56
    v_and_b32 v25, v21, v56
    v_and_b32 v26, v22, v56
    v_and_b32 v27, v23, v56
    s_nop 1
    v_mfma_f32_16x16x32_bf16 v[160:163], v[24:27], v[64:67], v[160:163]
    v_mfma_f32_16x16x32_bf16 v[164:167], v[24:27], v[68:71], v[164:167]
    v_mfma_f32_16x16x32_bf16 v[168:171], v[24:27], v[72:75], v[168:171]
    s_add_u32 m0, s85, 19456
    s_add_u32 s100, s91, 215040
    buffer_load_dwordx4 v2, s[36:39], s100 offen  lds
    s_waitcnt vmcnt(6)
    s_add_u32 s3, s80, 304128
    buffer_load_dwordx4 v[112:115], v1, s[32:35], s3 offen offset:0 nt
    buffer_load_dwordx4 v[116:119], v1, s[32:35], s3 offen offset:128 nt
    buffer_load_dwordx4 v[120:123], v1, s[32:35], s3 offen offset:256 nt
    s_add_u32 s24, s0, 17
    v_subrev_u32 v6, s24, v6
    v_cmp_gt_u32 s[68:69], 64, v6
    s_xor_b32 s24, s21, 30
    s_bitcmp1_b32 s68, s24
    s_cbranch_scc1 L_nh16_0
    s_xor_b32 s24, s25, 1008
    s_mul_i32 s24, s24, 393216
    s_add_u32 s24, s24, 304128
    buffer_load_dword a240, v16, s[32:35], s24 offen nt
    buffer_load_dword a240, v16, s[32:35], s24 offen
    s_branch L_nh16
L_nh16_0:
    s_xor_b32 s24, s21, 11
    s_bitcmp1_b32 s68, s24
    s_cbranch_scc1 L_nh16_1
    s_xor_b32 s24, s25, 337
    s_mul_i32 s24, s24, 393216
    s_add_u32 s24, s24, 310272
    buffer_load_dword a240, v16, s[32:35], s24 offen nt
    buffer_load_dword a240, v16, s[32:35], s24 offen
    s_branch L_nh16
L_nh16_1:
    s_xor_b32 s24, s21, 22
    s_bitcmp1_b32 s68, s24
    s_cbranch_scc1 L_nh16
    s_xor_b32 s24, s25, 928
    s_mul_i32 s24, s24, 393216
    s_add_u32 s24, s24, 316416
    buffer_load_dword a240, v16, s[32:35], s24 offen nt
    buffer_load_dword a240, v16, s[32:35], s24 offen
L_nh16:
    v_and_b32 v28, v20, v57
    v_and_b32 v29, v21, v57
    v_and_b32 v30, v22, v57
    v_and_b32 v31, v23, v57
    s_nop 1
    v_mfma_f32_16x16x32_bf16 v[160:163], v[28:31], v[76:79], v[160:163]
    v_mfma_f32_16x16x32_bf16 v[164:167], v[28:31], v[80:83], v[164:167]
    v_mfma_f32_16x16x32_bf16 v[168:171], v[28:31], v[84:87], v[168:171]
    s_waitcnt vmcnt(6)
    s_add_u32 s3, s80, 310272
    buffer_load_dwordx4 v[124:127], v1, s[32:35], s3 offen offset:0 nt
    v_and_b32 v24, v20, v58
    v_and_b32 v25, v21, v58
    v_and_b32 v26, v22, v58
    v_and_b32 v27, v23, v58
    s_nop 1
    v_mfma_f32_16x16x32_bf16 v[160:163], v[24:27], v[88:91], v[160:163]
    v_mfma_f32_16x16x32_bf16 v[164:167], v[24:27], v[92:95], v[164:167]
    v_mfma_f32_16x16x32_bf16 v[168:171], v[24:27], v[96:99], v[168:171]
    s_waitcnt vmcnt(6)
    s_add_u32 s3, s80, 316416
    buffer_load_dwordx4 v[136:139], v1, s[32:35], s3 offen offset:0 nt
    s_waitcnt vmcnt(6)
    s_add_u32 s3, s80, 322560
    buffer_load_dwordx4 v[148:151], v17, s[32:35], s3 offen offset:0 nt
    v_and_b32 v28, v20, v59
    v_and_b32 v29, v21, v59
    v_and_b32 v30, v22, v59
    v_and_b32 v31, v23, v59
    s_nop 1
    v_mfma_f32_16x16x32_bf16 v[160:163], v[28:31], v[100:103], v[160:163]
    v_mfma_f32_16x16x32_bf16 v[164:167], v[28:31], v[104:107], v[164:167]
    v_mfma_f32_16x16x32_bf16 v[168:171], v[28:31], v[108:111], v[168:171]
    s_waitcnt vmcnt(5)
    s_add_u32 s3, s80, 310272
    buffer_load_dwordx4 v[128:131], v1, s[32:35], s3 offen offset:128 nt
    s_waitcnt lgkmcnt(0)
    v_xor_b32 v8, 4, v3
    v_mov_b32 v9, 7
    ds_write_b32 v8, v9
    ds_read_b64_tr_b16 a[200:201], v4 offset:10240
    ds_read_b64_tr_b16 a[202:203], v4 offset:10752
    ds_read_b64_tr_b16 a[204:205], v4 offset:10272
    ds_read_b64_tr_b16 a[206:207], v4 offset:10784
    ds_read_b64_tr_b16 a[208:209], v4 offset:10304
    ds_read_b64_tr_b16 a[210:211], v4 offset:10816
    s_waitcnt vmcnt(5)
    s_add_u32 s3, s80, 316416
    buffer_load_dwordx4 v[140:143], v1, s[32:35], s3 offen offset:128 nt
    ds_read_b64_tr_b16 a[212:213], v4 offset:10336
    ds_read_b64_tr_b16 a[214:215], v4 offset:10848
    ds_read_b64_tr_b16 a[216:217], v4 offset:14336
    ds_read_b64_tr_b16 a[218:219], v4 offset:14848
    ds_read_b64_tr_b16 a[220:221], v4 offset:14368
    ds_read_b64_tr_b16 a[222:223], v4 offset:14880
    s_waitcnt vmcnt(5)
    s_add_u32 s3, s80, 322560
    buffer_load_dwordx4 v[152:155], v17, s[32:35], s3 offen offset:128 nt
    ds_read_b64_tr_b16 a[224:225], v4 offset:14400
    ds_read_b64_tr_b16 a[226:227], v4 offset:14912
    ds_read_b64_tr_b16 a[228:229], v4 offset:14432
    ds_read_b64_tr_b16 a[230:231], v4 offset:14944
    s_waitcnt vmcnt(5)
    s_add_u32 s3, s80, 310272
    buffer_load_dwordx4 v[132:135], v1, s[32:35], s3 offen offset:256 nt
    ds_read_b32 v8, v3
    s_waitcnt vmcnt(5)
    s_add_u32 s3, s80, 316416
    buffer_load_dwordx4 v[144:147], v1, s[32:35], s3 offen offset:256 nt
    s_waitcnt lgkmcnt(0)
    v_cmp_gt_u32 vcc, 7, v8
    s_nop 1
    s_cbranch_vccnz L_fb_h6
L_fb_h6_ret:
    ds_read_b64_tr_b16 a[232:233], v5 offset:18432
    ds_read_b64_tr_b16 a[234:235], v5 offset:18944
    s_waitcnt vmcnt(5)
    s_add_u32 s3, s80, 322560
    buffer_load_dwordx4 v[156:159], v17, s[32:35], s3 offen offset:256 nt
    ds_read_b64_tr_b16 a[236:237], v5 offset:18464
    ds_read_b64_tr_b16 a[238:239], v5 offset:18976
    v_and_b32 v24, v20, v60
    v_and_b32 v25, v21, v60
    v_and_b32 v26, v22, v60
    v_and_b32 v27, v23, v60
    s_nop 1
    v_mfma_f32_16x16x32_bf16 v[160:163], v[24:27], v[112:115], v[160:163]
    v_mfma_f32_16x16x32_bf16 v[164:167], v[24:27], v[116:119], v[164:167]
    v_mfma_f32_16x16x32_bf16 v[168:171], v[24:27], v[120:123], v[168:171]
    v_and_b32 v24, v20, v61
    v_and_b32 v25, v21, v61
    v_and_b32 v26, v22, v61
    v_and_b32 v27, v23, v61
    v_and_b32 v28, v20, v62
    v_and_b32 v29, v21, v62
    v_and_b32 v30, v22, v62
    v_and_b32 v31, v23, v62
    v_and_b32 v236, v20, v63
    v_and_b32 v237, v21, v63
    v_and_b32 v238, v22, v63
    v_and_b32 v239, v23, v63
    v_mfma_f32_16x16x32_bf16 v[160:163], v[24:27], v[124:127], v[160:163]
    v_mfma_f32_16x16x32_bf16 v[160:163], v[28:31], v[136:139], v[160:163]
    v_mfma_f32_16x16x32_bf16 v[160:163], v[236:239], v[148:151], v[160:163]
    s_nop 7
    v_cvt_pk_bf16_f32 v8, v160, v161
    v_cvt_pk_bf16_f32 v9, v162, v163
    ds_write_b64 v251, v[8:9] offset:0
    s_waitcnt lgkmcnt(0)
    s_barrier
    ds_read_b128 v[212:215], v252 offset:0
    ds_read_b128 v[216:219], v252 offset:64
    s_waitcnt lgkmcnt(1)
    v_mfma_f32_16x16x32_bf16 v[172:175], v[212:215], a[0:3], v[172:175]
    v_mfma_f32_16x16x32_bf16 v[176:179], v[212:215], a[4:7], v[176:179]
    s_waitcnt lgkmcnt(0)
    v_mfma_f32_16x16x32_bf16 v[172:175], v[216:219], a[40:43], v[172:175]
    v_mfma_f32_16x16x32_bf16 v[176:179], v[216:219], a[44:47], v[176:179]
    v_mfma_f32_16x16x32_bf16 v[180:183], v[212:215], a[8:11], v[180:183]
    v_mfma_f32_16x16x32_bf16 v[184:187], v[212:215], a[12:15], v[184:187]
    v_mfma_f32_16x16x32_bf16 v[180:183], v[216:219], a[48:51], v[180:183]
    v_mfma_f32_16x16x32_bf16 v[184:187], v[216:219], a[52:55], v[184:187]
    v_mfma_f32_16x16x32_bf16 v[188:191], v[212:215], a[16:19], v[188:191]
    v_mfma_f32_16x16x32_bf16 v[192:195], v[212:215], a[20:23], v[192:195]
    v_mfma_f32_16x16x32_bf16 v[188:191], v[216:219], a[56:59], v[188:191]
    v_mfma_f32_16x16x32_bf16 v[192:195], v[216:219], a[60:63], v[192:195]
    v_mfma_f32_16x16x32_bf16 v[196:199], v[212:215], a[24:27], v[196:199]
    v_mfma_f32_16x16x32_bf16 v[200:203], v[212:215], a[28:31], v[200:203]
    v_mfma_f32_16x16x32_bf16 v[196:199], v[216:219], a[64:67], v[196:199]
    v_mfma_f32_16x16x32_bf16 v[200:203], v[216:219], a[68:71], v[200:203]
    v_mfma_f32_16x16x32_bf16 v[204:207], v[212:215], a[32:35], v[204:207]
    v_mfma_f32_16x16x32_bf16 v[208:211], v[212:215], a[36:39], v[208:211]
    v_mfma_f32_16x16x32_bf16 v[204:207], v[216:219], a[72:75], v[204:207]
    v_mfma_f32_16x16x32_bf16 v[208:211], v[216:219], a[76:79], v[208:211]
    s_waitcnt vmcnt(5)
    v_mfma_f32_16x16x32_bf16 v[164:167], v[24:27], v[128:131], v[164:167]
    s_waitcnt vmcnt(4)
    v_mfma_f32_16x16x32_bf16 v[164:167], v[28:31], v[140:143], v[164:167]
    s_waitcnt vmcnt(3)
    v_mfma_f32_16x16x32_bf16 v[164:167], v[236:239], v[152:155], v[164:167]
    s_nop 7
    v_cvt_pk_bf16_f32 v8, v164, v165
    v_cvt_pk_bf16_f32 v9, v166, v167
    ds_write_b64 v251, v[8:9] offset:128
    s_waitcnt lgkmcnt(0)
    s_barrier
    ds_read_b128 v[220:223], v252 offset:128
    ds_read_b128 v[224:227], v252 offset:192
    s_waitcnt lgkmcnt(1)
    v_mfma_f32_16x16x32_bf16 v[172:175], v[220:223], a[80:83], v[172:175]
    v_mfma_f32_16x16x32_bf16 v[176:179], v[220:223], a[84:87], v[176:179]
    s_waitcnt lgkmcnt(0)
    v_mfma_f32_16x16x32_bf16 v[172:175], v[224:227], a[120:123], v[172:175]
    v_mfma_f32_16x16x32_bf16 v[176:179], v[224:227], a[124:127], v[176:179]
    v_mfma_f32_16x16x32_bf16 v[180:183], v[220:223], a[88:91], v[180:183]
    v_mfma_f32_16x16x32_bf16 v[184:187], v[220:223], a[92:95], v[184:187]
    v_mfma_f32_16x16x32_bf16 v[180:183], v[224:227], a[128:131], v[180:183]
    v_mfma_f32_16x16x32_bf16 v[184:187], v[224:227], a[132:135], v[184:187]
    v_mfma_f32_16x16x32_bf16 v[188:191], v[220:223], a[96:99], v[188:191]
    v_mfma_f32_16x16x32_bf16 v[192:195], v[220:223], a[100:103], v[192:195]
    v_mfma_f32_16x16x32_bf16 v[188:191], v[224:227], a[136:139], v[188:191]
    v_mfma_f32_16x16x32_bf16 v[192:195], v[224:227], a[140:143], v[192:195]
    v_mfma_f32_16x16x32_bf16 v[196:199], v[220:223], a[104:107], v[196:199]
    v_mfma_f32_16x16x32_bf16 v[200:203], v[220:223], a[108:111], v[200:203]
    v_mfma_f32_16x16x32_bf16 v[196:199], v[224:227], a[144:147], v[196:199]
    v_mfma_f32_16x16x32_bf16 v[200:203], v[224:227], a[148:151], v[200:203]
    v_mfma_f32_16x16x32_bf16 v[204:207], v[220:223], a[112:115], v[204:207]
    v_mfma_f32_16x16x32_bf16 v[208:211], v[220:223], a[116:119], v[208:211]
    v_mfma_f32_16x16x32_bf16 v[204:207], v[224:227], a[152:155], v[204:207]
    v_mfma_f32_16x16x32_bf16 v[208:211], v[224:227], a[156:159], v[208:211]
    s_waitcnt vmcnt(2)
    v_mfma_f32_16x16x32_bf16 v[168:171], v[24:27], v[132:135], v[168:171]
    s_waitcnt vmcnt(1)
    v_mfma_f32_16x16x32_bf16 v[168:171], v[28:31], v[144:147], v[168:171]
    s_waitcnt vmcnt(0)
    v_mfma_f32_16x16x32_bf16 v[168:171], v[236:239], v[156:159], v[168:171]
    s_nop 7
    v_cvt_pk_bf16_f32 v8, v168, v169
    v_cvt_pk_bf16_f32 v9, v170, v171
    ds_write_b64 v251, v[8:9] offset:256
    s_waitcnt lgkmcnt(0)
    s_barrier
    ds_read_b128 v[228:231], v252 offset:256
    ds_read_b128 v[232:235], v252 offset:320
    s_waitcnt lgkmcnt(1)
    v_mfma_f32_16x16x32_bf16 v[172:175], v[228:231], a[160:163], v[172:175]
    v_mfma_f32_16x16x32_bf16 v[176:179], v[228:231], a[164:167], v[176:179]
    s_waitcnt lgkmcnt(0)
    v_mfma_f32_16x16x32_bf16 v[172:175], v[232:235], a[200:203], v[172:175]
    v_mfma_f32_16x16x32_bf16 v[176:179], v[232:235], a[204:207], v[176:179]
    v_mfma_f32_16x16x32_bf16 v[180:183], v[228:231], a[168:171], v[180:183]
    v_mfma_f32_16x16x32_bf16 v[184:187], v[228:231], a[172:175], v[184:187]
    v_mfma_f32_16x16x32_bf16 v[180:183], v[232:235], a[208:211], v[180:183]
    v_mfma_f32_16x16x32_bf16 v[184:187], v[232:235], a[212:215], v[184:187]
    v_mfma_f32_16x16x32_bf16 v[188:191], v[228:231], a[176:179], v[188:191]
    s_nop 1
    v_pk_add_f32 v[172:173], v[172:173], v[174:175]
    v_pk_add_f32 v[176:177], v[176:177], v[178:179]
    v_mfma_f32_16x16x32_bf16 v[192:195], v[228:231], a[180:183], v[192:195]
    v_add_f32 v172, v172, v173
    v_add_f32 v176, v176, v177
    v_mfma_f32_16x16x32_bf16 v[188:191], v[232:235], a[216:219], v[188:191]
    s_nop 0
    v_permlane16_swap_b32 v172, v176
    v_add_f32 v172, v172, v176
    v_mfma_f32_16x16x32_bf16 v[192:195], v[232:235], a[220:223], v[192:195]
    v_bfi_b32 v172, 63, s60, v172
    buffer_store_dword v172, v253, s[48:51], s98 offen offset:0 sc1
    v_mfma_f32_16x16x32_bf16 v[196:199], v[228:231], a[184:187], v[196:199]
    v_pk_add_f32 v[180:181], v[180:181], v[182:183]
    v_pk_add_f32 v[184:185], v[184:185], v[186:187]
    v_mfma_f32_16x16x32_bf16 v[200:203], v[228:231], a[188:191], v[200:203]
    v_add_f32 v180, v180, v181
    v_add_f32 v184, v184, v185
    v_mfma_f32_16x16x32_bf16 v[196:199], v[232:235], a[224:227], v[196:199]
    s_nop 0
    v_permlane16_swap_b32 v180, v184
    v_add_f32 v180, v180, v184
    v_mfma_f32_16x16x32_bf16 v[200:203], v[232:235], a[228:231], v[200:203]
    v_bfi_b32 v180, 63, s60, v180
    buffer_store_dword v180, v253, s[48:51], s98 offen offset:128 sc1
    v_mfma_f32_16x16x32_bf16 v[204:207], v[228:231], a[192:195], v[204:207]
    v_pk_add_f32 v[188:189], v[188:189], v[190:191]
    v_pk_add_f32 v[192:193], v[192:193], v[194:195]
    v_mfma_f32_16x16x32_bf16 v[208:211], v[228:231], a[196:199], v[208:211]
    v_add_f32 v188, v188, v189
    v_add_f32 v192, v192, v193
    v_mfma_f32_16x16x32_bf16 v[204:207], v[232:235], a[232:235], v[204:207]
    s_nop 0
    v_permlane16_swap_b32 v188, v192
    v_add_f32 v188, v188, v192
    v_mfma_f32_16x16x32_bf16 v[208:211], v[232:235], a[236:239], v[208:211]
    v_bfi_b32 v188, 63, s60, v188
    buffer_store_dword v188, v253, s[48:51], s98 offen offset:256 sc1
    v_pk_add_f32 v[196:197], v[196:197], v[198:199]
    v_pk_add_f32 v[200:201], v[200:201], v[202:203]
    v_add_f32 v196, v196, v197
    v_add_f32 v200, v200, v201
    s_nop 1
    v_permlane16_swap_b32 v196, v200
    v_add_f32 v196, v196, v200
    v_bfi_b32 v196, 63, s60, v196
    buffer_store_dword v196, v253, s[48:51], s98 offen offset:384 sc1
    v_pk_add_f32 v[204:205], v[204:205], v[206:207]
    v_pk_add_f32 v[208:209], v[208:209], v[210:211]
    v_add_f32 v204, v204, v205
    v_add_f32 v208, v208, v209
    s_nop 1
    v_permlane16_swap_b32 v204, v208
    v_add_f32 v204, v204, v208
    v_bfi_b32 v204, 63, s60, v204
    buffer_store_dword v204, v253, s[48:51], s99 offen sc1
    s_cmp_ge_u32 s57, 80
    s_cbranch_scc1 L_help
    buffer_load_dwordx4 v[64:67], v255, s[48:51], 0 offen sc1
    buffer_load_dwordx4 v[68:71], v255, s[48:51], s58 offen sc1
    s_mov_b32 s89, 1048576
    s_lshl2_add_u32 s82, s72, 137600
    v_lshlrev_b32 v12, 4, v0
    v_add_u32 v13, s82, v12
    v_add_u32 v12, 137600, v12
    buffer_load_dwordx4 v[72:75], v255, s[48:51], 0 offen sc1
    buffer_load_dwordx4 v[76:79], v255, s[48:51], s58 offen sc1
    buffer_load_dwordx4 v[80:83], v255, s[48:51], 0 offen sc1
    buffer_load_dwordx4 v[84:87], v255, s[48:51], s58 offen sc1
L_cpoll:
    s_waitcnt vmcnt(5)
    v_xor_b32 v64, s61, v64
    v_xor_b32 v65, s61, v65
    v_xor_b32 v66, s61, v66
    v_xor_b32 v67, s61, v67
    v_or_b32 v10, v64, v65
    v_or_b32 v11, v66, v67
    s_waitcnt vmcnt(4)
    v_xor_b32 v68, s61, v68
    v_xor_b32 v69, s61, v69
    v_xor_b32 v70, s61, v70
    v_xor_b32 v71, s61, v71
    v_or3_b32 v10, v10, v68, v69
    v_or3_b32 v11, v11, v70, v71
    v_pk_add_f32 v[128:129], v[64:65], v[68:69]
    v_pk_add_f32 v[130:131], v[66:67], v[70:71]
    v_bitop3_b32 v10, v10, 63, v11 bitop3:0xc8
    v_permlane32_swap_b32 v128, v129
    v_permlane32_swap_b32 v130, v131
    v_cmp_ne_u32 vcc, 0, v10
    v_add_f32 v128, v128, v129
    v_add_f32 v130, v130, v131
    s_cbranch_vccz L_cdone
    buffer_load_dwordx4 v[64:67], v255, s[48:51], 0 offen sc1
    buffer_load_dwordx4 v[68:71], v255, s[48:51], s58 offen sc1
    s_waitcnt vmcnt(5)
    v_xor_b32 v72, s61, v72
    v_xor_b32 v73, s61, v73
    v_xor_b32 v74, s61, v74
    v_xor_b32 v75, s61, v75
    v_or_b32 v10, v72, v73
    v_or_b32 v11, v74, v75
    s_waitcnt vmcnt(4)
    v_xor_b32 v76, s61, v76
    v_xor_b32 v77, s61, v77
    v_xor_b32 v78, s61, v78
    v_xor_b32 v79, s61, v79
    v_or3_b32 v10, v10, v76, v77
    v_or3_b32 v11, v11, v78, v79
    v_pk_add_f32 v[128:129], v[72:73], v[76:77]
    v_pk_add_f32 v[130:131], v[74:75], v[78:79]
    v_bitop3_b32 v10, v10, 63, v11 bitop3:0xc8
    v_permlane32_swap_b32 v128, v129
    v_permlane32_swap_b32 v130, v131
    v_cmp_ne_u32 vcc, 0, v10
    v_add_f32 v128, v128, v129
    v_add_f32 v130, v130, v131
    s_cbranch_vccz L_cdone
    buffer_load_dwordx4 v[72:75], v255, s[48:51], 0 offen sc1
    buffer_load_dwordx4 v[76:79], v255, s[48:51], s58 offen sc1
    s_waitcnt vmcnt(5)
    v_xor_b32 v80, s61, v80
    v_xor_b32 v81, s61, v81
    v_xor_b32 v82, s61, v82
    v_xor_b32 v83, s61, v83
    v_or_b32 v10, v80, v81
    v_or_b32 v11, v82, v83
    s_waitcnt vmcnt(4)
    v_xor_b32 v84, s61, v84
    v_xor_b32 v85, s61, v85
    v_xor_b32 v86, s61, v86
    v_xor_b32 v87, s61, v87
    v_or3_b32 v10, v10, v84, v85
    v_or3_b32 v11, v11, v86, v87
    v_pk_add_f32 v[128:129], v[80:81], v[84:85]
    v_pk_add_f32 v[130:131], v[82:83], v[86:87]
    v_bitop3_b32 v10, v10, 63, v11 bitop3:0xc8
    v_permlane32_swap_b32 v128, v129
    v_permlane32_swap_b32 v130, v131
    v_cmp_ne_u32 vcc, 0, v10
    v_add_f32 v128, v128, v129
    v_add_f32 v130, v130, v131
    s_cbranch_vccz L_cdone
    buffer_load_dwordx4 v[80:83], v255, s[48:51], 0 offen sc1
    buffer_load_dwordx4 v[84:87], v255, s[48:51], s58 offen sc1
    s_sub_u32 s89, s89, 1
    s_cmp_lg_u32 s89, 0
    s_cbranch_scc1 L_cpoll
L_cdone:
    s_nop 0
    s_nop 0
    v_permlane16_swap_b32 v128, v130
    v_add_f32 v128, v128, v130
    s_nop 1
    v_add_f32_dpp v128, v128, v128 row_ror:8 row_mask:0xf bank_mask:0xf
    ds_write_b32 v13, v128
    s_cmp_lg_u32 s72, 0
    s_waitcnt lgkmcnt(0)
    s_barrier
    s_cbranch_scc1 L_fin
    ds_read_b128 v[128:131], v12
    s_waitcnt lgkmcnt(0)
    v_pk_add_f32 v[128:129], v[128:129], v[130:131]
    v_add_f32 v128, v128, v129
    v_add_f32 v128, v128, v250
    v_cvt_pk_bf16_f32 v128, v128, v128
    buffer_store_short v128, v254, s[64:67], s59 offen
    s_cmp_lg_u32 s57, 0
    s_cbranch_scc1 L_fin
    v_mov_b32 v8, s60
    s_mov_b32 s81, 0x68000
    buffer_store_dword v8, v18, s[48:51], s81 offen
    s_branch L_fin
L_help:
L_fin:
L_end:
    s_endpgm
L_fb_ep:
    s_mov_b32 s89, 131072
L_fb_ep_loop:
    s_sleep 2
    buffer_load_dwordx4 v[32:35], v6, s[48:51], 0 offen offset:0 sc1
    buffer_load_dwordx4 v[36:39], v6, s[48:51], 0 offen offset:1536 sc1
    s_waitcnt vmcnt(0)
    v_xor_b32 v8, s60, v32
    v_bitop3_b32 v8, v33, v8, s60 bitop3:0xde
    v_bitop3_b32 v8, v34, v8, s60 bitop3:0xde
    v_bitop3_b32 v8, v35, v8, s60 bitop3:0xde
    v_bitop3_b32 v8, v36, v8, s60 bitop3:0xde
    v_bitop3_b32 v8, v37, v8, s60 bitop3:0xde
    v_bitop3_b32 v8, v38, v8, s60 bitop3:0xde
    v_bitop3_b32 v8, v39, v8, s60 bitop3:0xde
    v_and_b32 v8, 7, v8
    v_cmp_ne_u32 vcc, 0, v8
    s_nop 1
    s_and_b64 vcc, vcc, s[62:63]
    s_nop 4
    s_cbranch_vccz L_fb_ep_ret
    s_sub_u32 s89, s89, 1
    s_cmp_lg_u32 s89, 0
    s_cbranch_scc1 L_fb_ep_loop
    s_branch L_fb_ep_ret
L_fb_q:
    s_mov_b32 s89, 8388608
L_fb_q_loop:
    s_sleep 2
    ds_read_b128 v[8:11], v12
    ds_read_b128 v[20:23], v17 offset:0
    ds_read_b128 v[24:27], v17 offset:128
    ds_read_b128 v[28:31], v17 offset:256
    s_waitcnt lgkmcnt(0)
    v_and_b32 v8, v8, v9
    v_and_b32 v10, v10, v11
    v_and_b32 v8, v8, v10
    v_cmp_ne_u32 vcc, 1, v8
    s_nop 4
    s_cbranch_vccz L_fb_q_ret
    s_sub_u32 s89, s89, 1
    s_cmp_lg_u32 s89, 0
    s_cbranch_scc1 L_fb_q_loop
    s_branch L_fb_q_ret
L_fb_h0:
    s_mov_b32 s89, 8388608
L_fb_h0_loop:
    s_sleep 2
    ds_read_b32 v8, v3
    s_waitcnt lgkmcnt(0)
    v_cmp_gt_u32 vcc, 1, v8
    s_nop 4
    s_cbranch_vccz L_fb_h0_ret
    s_sub_u32 s89, s89, 1
    s_cmp_lg_u32 s89, 0
    s_cbranch_scc1 L_fb_h0_loop
    s_branch L_fb_h0_ret
L_fb_h1:
    s_mov_b32 s89, 8388608
L_fb_h1_loop:
    s_sleep 2
    ds_read_b32 v8, v3
    s_waitcnt lgkmcnt(0)
    v_cmp_gt_u32 vcc, 2, v8
    s_nop 4
    s_cbranch_vccz L_fb_h1_ret
    s_sub_u32 s89, s89, 1
    s_cmp_lg_u32 s89, 0
    s_cbranch_scc1 L_fb_h1_loop
    s_branch L_fb_h1_ret
L_fb_h2:
    s_mov_b32 s89, 8388608
L_fb_h2_loop:
    s_sleep 2
    ds_read_b32 v8, v3
    s_waitcnt lgkmcnt(0)
    v_cmp_gt_u32 vcc, 3, v8
    s_nop 4
    s_cbranch_vccz L_fb_h2_ret
    s_sub_u32 s89, s89, 1
    s_cmp_lg_u32 s89, 0
    s_cbranch_scc1 L_fb_h2_loop
    s_branch L_fb_h2_ret
L_fb_h3:
    s_mov_b32 s89, 8388608
L_fb_h3_loop:
    s_sleep 2
    ds_read_b32 v8, v3
    s_waitcnt lgkmcnt(0)
    v_cmp_gt_u32 vcc, 4, v8
    s_nop 4
    s_cbranch_vccz L_fb_h3_ret
    s_sub_u32 s89, s89, 1
    s_cmp_lg_u32 s89, 0
    s_cbranch_scc1 L_fb_h3_loop
    s_branch L_fb_h3_ret
L_fb_h4:
    s_mov_b32 s89, 8388608
L_fb_h4_loop:
    s_sleep 2
    ds_read_b32 v8, v3
    s_waitcnt lgkmcnt(0)
    v_cmp_gt_u32 vcc, 5, v8
    s_nop 4
    s_cbranch_vccz L_fb_h4_ret
    s_sub_u32 s89, s89, 1
    s_cmp_lg_u32 s89, 0
    s_cbranch_scc1 L_fb_h4_loop
    s_branch L_fb_h4_ret
L_fb_h5:
    s_mov_b32 s89, 8388608
L_fb_h5_loop:
    s_sleep 2
    ds_read_b32 v8, v3
    s_waitcnt lgkmcnt(0)
    v_cmp_gt_u32 vcc, 6, v8
    s_nop 4
    s_cbranch_vccz L_fb_h5_ret
    s_sub_u32 s89, s89, 1
    s_cmp_lg_u32 s89, 0
    s_cbranch_scc1 L_fb_h5_loop
    s_branch L_fb_h5_ret
L_fb_ml:
    s_mov_b32 s89, 131072
L_fb_ml_loop:
    s_sleep 2
    buffer_load_dwordx4 v[246:249], v245, s[48:51], s93 offen sc1
    s_waitcnt vmcnt(0)
    v_xor_b32 v8, s60, v247
    v_bitop3_b32 v8, v249, v8, s60 bitop3:0xde
    v_cmp_ne_u32 vcc, 0, v8
    s_nop 4
    s_cbranch_vccz L_fb_ml_ret
    s_sub_u32 s89, s89, 1
    s_cmp_lg_u32 s89, 0
    s_cbranch_scc1 L_fb_ml_loop
    s_branch L_fb_ml_ret
L_fb_h6:
    s_mov_b32 s89, 8388608
L_fb_h6_loop:
    s_sleep 2
    ds_read_b32 v8, v3
    s_waitcnt lgkmcnt(0)
    v_cmp_gt_u32 vcc, 7, v8
    s_nop 4
    s_cbranch_vccz L_fb_h6_ret
    s_sub_u32 s89, s89, 1
    s_cmp_lg_u32 s89, 0
    s_cbranch_scc1 L_fb_h6_loop
    s_branch L_fb_h6_ret
.section .rodata,"a"
.p2align 6
.amdhsa_kernel parallel_sum__sliding_block_cached__glu_gated_swiglu__decode_kernel
  .amdhsa_next_free_vgpr 512
  .amdhsa_next_free_sgpr 102
  .amdhsa_accum_offset 256
  .amdhsa_group_segment_fixed_size 0
  .amdhsa_kernarg_size 96
  .amdhsa_user_sgpr_count 2
  .amdhsa_user_sgpr_kernarg_segment_ptr 1
  .amdhsa_system_sgpr_workgroup_id_x 1
  .amdhsa_float_denorm_mode_32 3
  .amdhsa_float_denorm_mode_16_64 3
.end_amdhsa_kernel
```
